```python
import torch

def _softmax(x, axis=-1):
    return torch.softmax(x, dim=axis)
def _gelu(x):
    return torch.nn.functional.gelu(x, approximate="tanh")
def _silu(x):
    return torch.nn.functional.silu(x)
def _sigmoid(x):
    return torch.sigmoid(x)
def _layernorm(x, axis=-1, eps=1e-5):
    m = x.mean(dim=axis, keepdim=True)
    v = x.var(dim=axis, keepdim=True, unbiased=False)
    return (x - m) / torch.sqrt(v + eps)
def _scatter_add(tgt, idx, src, axis=0):
    return tgt.clone().index_add_(axis, idx, src)
def _segment_sum(src, seg, n):
    out = torch.zeros((n,) + src.shape[1:], dtype=src.dtype)
    return out.index_add_(0, seg, src)
def _pad(x, pw):
    flat = tuple(v for pair in reversed(pw) for v in pair)
    return torch.nn.functional.pad(x, flat)

kernel_name = 'recurrent_scan__sliding_block_cached__mixer_token_mlp__decode'

def setup_inputs():

    _w = (lambda a: (lambda t: t.to(torch.bfloat16) if t.is_floating_point() else t)(torch.as_tensor(a)))
    def _A_setup():
        B, Sq, D = 4, 1, 576
        Hq, Hkv, Sk, Dh = 32, 16, 8192, 128
        assert Hq % Hkv == 0, (Hq, Hkv)
        return {
            "x": _w((lambda *s: torch.randn(*s, dtype=torch.bfloat16) * 0.05)(B, Sq, D)),
            "k_cache": _w((lambda *s: torch.randn(*s, dtype=torch.bfloat16) * 1.6)(B, Hkv, Sk, Dh)),
            "v_cache": _w((lambda *s: torch.randn(*s, dtype=torch.bfloat16) * 1.6)(B, Hkv, Sk, Dh)),
            "wq": _w((lambda *s: torch.randn(*s, dtype=torch.bfloat16) * 1.6)(D, Hq * Dh) * (D ** -0.5)),
            "wo": _w((lambda *s: torch.randn(*s, dtype=torch.bfloat16) * 1.6)(Hq * Dh, D) * ((Hq * Dh) ** -0.5)),
        }
    _A_in = _A_setup()

    def _B_setup():
        B, S, D, F = 4, 1, 576, 4608
        return {
            "x": _w((lambda *s: torch.randn(*s, dtype=torch.bfloat16) * 0.05)(B, S, D)),
            "w1": _w((lambda *s: torch.randn(*s, dtype=torch.bfloat16) * 0.2)(S, F) * (S ** -0.5)),
            "b1": _w((lambda *s: torch.randn(*s, dtype=torch.bfloat16) * 0.2)(F) * 0.02),
            "w2": _w((lambda *s: torch.randn(*s, dtype=torch.bfloat16) * 0.2)(F, S) * (F ** -0.5)),
            "b2": _w((lambda *s: torch.randn(*s, dtype=torch.bfloat16) * 0.2)(S) * 0.02),
        }
    _B_in = _B_setup()

    return {
        "A_x": _A_in["x"],
        "A_k_cache": _A_in["k_cache"],
        "A_v_cache": _A_in["v_cache"],
        "A_wq": _A_in["wq"],
        "A_wo": _A_in["wo"],
        "B_x": _B_in["x"],
        "B_w1": _B_in["w1"],
        "B_b1": _B_in["b1"],
        "B_w2": _B_in["w2"],
        "B_b2": _B_in["b2"],
    }

def reference(A_x, A_k_cache, A_v_cache, A_wq, A_wo, B_x, B_w1, B_b1, B_w2, B_b2):
    def _A_ref(x, k_cache, v_cache, wq, wo):
        B, Sq, D = x.shape
        Hq, Dh = 32, 128
        Hkv, Sk = k_cache.shape[1], k_cache.shape[2]
        W = min(4096, max(256, Sk // 4))
        rep = Hq // Hkv
        q = (lambda x, *d: x.permute(*d))((x @ wq).reshape(B, Sq, Hq, Dh), 0, 2, 1, 3)
        k = (lambda x, n, axis: torch.repeat_interleave(x, n, dim=axis))(k_cache[:, :, Sk - W:, :], rep, axis=1)
        v = (lambda x, n, axis: torch.repeat_interleave(x, n, dim=axis))(v_cache[:, :, Sk - W:, :], rep, axis=1)
        scores = torch.einsum("bhqd,bhkd->bhqk", q, k) * (Dh ** -0.5)
        p = _softmax(scores, axis=-1)
        o = torch.einsum("bhqk,bhkd->bhqd", p, v)
        return (lambda x, *d: x.permute(*d))(o, 0, 2, 1, 3).reshape(B, Sq, Hq * Dh) @ wo

    def _B_ref(x, w1, b1, w2, b2):
        B, S, D = x.shape
        h = _layernorm(x, axis=-1)
        u = torch.einsum("bsd,sf->bdf", h, w1) + b1
        u = _gelu(u)
        y = torch.einsum("bdf,fs->bds", u, w2) + b2
        return (lambda x, *d: x.permute(*d))(y, 0, 2, 1)

    x = A_x
    xn = _layernorm(x, axis=-1)
    s = _A_ref(xn, A_k_cache, A_v_cache, A_wq, A_wo)
    g = _silu(_B_ref(xn, B_w1, B_b1, B_w2, B_b2))
    return x + s * g
```

```asm
; @launch grid=(256,1,1) block=(768,1,1) lds=49824
.amdgcn_target "amdgcn-amd-amdhsa--gfx950"
.text
.globl recurrent_scan__sliding_block_cached__mixer_token_mlp__decode_kernel
.p2align 8
.type recurrent_scan__sliding_block_cached__mixer_token_mlp__decode_kernel,@function
recurrent_scan__sliding_block_cached__mixer_token_mlp__decode_kernel:
    s_cmp_ge_u32 s2, 256
    s_cbranch_scc1 L_end
    s_load_dwordx16 s[4:19], s[0:1], 0
    s_load_dwordx8 s[20:27], s[0:1], 64
    s_load_dwordx2 s[28:29], s[0:1], 96
    v_lshrrev_b32 v1, 6, v0
    v_and_b32 v0, 63, v0
    v_readfirstlane_b32 s3, v1
    s_and_b32 s76, s2, 7
    s_lshr_b32 s77, s2, 3
    s_lshl_b32 s76, s76, 1
    s_lshr_b32 s78, s77, 4
    s_add_u32 s76, s76, s78
    s_and_b32 s77, s77, 15
    s_lshr_b32 s78, s77, 2
    s_and_b32 s79, s77, 3
    s_lshl_b32 s81, s76, 4
    s_add_u32 s81, s81, s77
    s_cmp_lt_u32 s3, 4
    s_cbranch_scc1 L_service
    s_sub_u32 s82, s3, 4
    s_setprio 1
    s_lshl_b32 s83, s78, 4
    s_add_u32 s83, s83, s76
    s_lshl_b32 s83, s83, 21
    s_lshl_b32 s84, s79, 17
    s_add_u32 s83, s83, s84
    s_lshl_b32 s84, s82, 12
    s_add_u32 s83, s83, s84
    s_add_u32 s83, s83, 0x180000
    v_bfe_u32 v1, v0, 2, 2
    v_lshlrev_b32 v1, 8, v1
    v_lshrrev_b32 v2, 4, v0
    v_lshl_add_u32 v1, v2, 6, v1
    v_and_b32 v2, 3, v0
    v_lshl_add_u32 v1, v2, 4, v1
    v_add_u32 v1, s83, v1
    v_lshl_add_u32 v2, v0, 4, s83
    s_mov_b32 s44, 0x8000
    s_mov_b32 s45, 0x10000
    s_mov_b32 s46, 0x18000
    s_waitcnt lgkmcnt(0)
    s_mov_b32 s32, s6
    s_mov_b32 s33, s7
    s_mov_b32 s34, 0x8000000
    s_mov_b32 s35, 0x20000
    buffer_load_dwordx4 v[40:43], v1, s[32:35], 0 offen offset:0 nt
    s_barrier
    buffer_load_dwordx4 v[44:47], v1, s[32:35], 0 offen offset:1024 nt
    buffer_load_dwordx4 v[48:51], v1, s[32:35], 0 offen offset:2048 nt
    buffer_load_dwordx4 v[52:55], v1, s[32:35], 0 offen offset:3072 nt
    s_load_dword s80, s[28:29], 0
    s_mov_b32 s36, s8
    s_mov_b32 s37, s9
    s_mov_b32 s38, 0x8000000
    s_mov_b32 s39, 0x20000
    s_mov_b32 s40, s28
    s_mov_b32 s41, s29
    s_mov_b32 s42, 0x20000000
    s_mov_b32 s43, 0x20000
    v_mov_b32 v3, 0x3f800000
    v_bfe_u32 v34, v0, 1, 1
    v_bfe_u32 v35, v0, 3, 1
    v_lshl_add_u32 v34, v35, 1, v34
    v_and_b32 v35, 1, v0
    v_lshlrev_b32 v35, 4, v35
    v_mov_b32 v36, 0xffff
    v_lshlrev_b32 v35, v35, v36
    v_cmp_eq_u32 vcc, 0, v34
    s_nop 1
    v_cndmask_b32 v4, 0, v35, vcc
    v_cmp_eq_u32 vcc, 1, v34
    s_nop 1
    v_cndmask_b32 v5, 0, v35, vcc
    v_cmp_eq_u32 vcc, 2, v34
    s_nop 1
    v_cndmask_b32 v6, 0, v35, vcc
    v_cmp_eq_u32 vcc, 3, v34
    s_nop 1
    v_cndmask_b32 v7, 0, v35, vcc
    s_mov_b32 s31, s82
    v_and_b32 v34, 3, v0
    v_lshrrev_b32 v39, 4, v0
    v_lshlrev_b32 v37, 7, v34
    v_lshl_add_u32 v37, v39, 4, v37
    v_add_u32 v37, 49184, v37
    v_bfe_u32 v38, v0, 2, 2
    v_lshl_add_u32 v38, v39, 2, v38
    v_mul_u32_u24 v38, 288, v38
    v_lshl_add_u32 v38, v34, 3, v38
    s_lshl_b32 s83, s31, 5
    s_add_u32 s83, s83, 18432
    v_add_u32 v38, s83, v38
    v_lshlrev_b32 v39, 4, v39
    v_mul_u32_u24 v34, 147456, v34
    v_add_u32 v39, v39, v34
    s_mul_i32 s83, s79, 9
    s_add_u32 s83, s83, s31
    s_lshl_b32 s83, s83, 12
    s_lshr_b32 s84, s81, 2
    s_lshl_b32 s84, s84, 6
    s_add_u32 s83, s83, s84
    s_add_u32 s83, s83, 589824
    v_add_u32 v39, s83, v39
    v_bfe_u32 v34, v0, 2, 1
    v_lshlrev_b32 v34, 8, v34
    v_lshrrev_b32 v35, 4, v0
    v_lshl_add_u32 v34, v35, 6, v34
    v_and_b32 v35, 3, v0
    v_lshl_add_u32 v34, v35, 4, v34
    v_mov_b32 v35, 0
    s_movk_i32 s101, 0xff
    s_waitcnt lgkmcnt(0)
    s_and_b32 s100, s80, 0xff
    s_andn2_b32 s80, s80, 0xff
    s_cmp_eq_u32 s100, 0xff
    s_cselect_b32 s100, 0, s100
    s_add_u32 s100, s100, 1
    s_add_u32 s80, s80, 0x9E377900
    s_or_b32 s80, s80, s100
    s_waitcnt vmcnt(3)
    buffer_load_dwordx4 v[56:59], v1, s[32:35], s44 offen offset:0 nt
    s_waitcnt vmcnt(3)
    buffer_load_dwordx4 v[60:63], v1, s[32:35], s44 offen offset:1024 nt
    s_waitcnt vmcnt(3)
    buffer_load_dwordx4 v[64:67], v1, s[32:35], s44 offen offset:2048 nt
    s_waitcnt vmcnt(3)
    buffer_load_dwordx4 v[68:71], v1, s[32:35], s44 offen offset:3072 nt
    s_waitcnt vmcnt(3)
    buffer_load_dwordx4 v[72:75], v1, s[32:35], s45 offen offset:0 nt
    s_waitcnt vmcnt(3)
    buffer_load_dwordx4 v[76:79], v1, s[32:35], s45 offen offset:1024 nt
    s_waitcnt vmcnt(3)
    buffer_load_dwordx4 v[80:83], v1, s[32:35], s45 offen offset:2048 nt
    s_waitcnt vmcnt(3)
    buffer_load_dwordx4 v[84:87], v1, s[32:35], s45 offen offset:3072 nt
    s_waitcnt vmcnt(3)
    buffer_load_dwordx4 v[88:91], v1, s[32:35], s46 offen offset:0 nt
    s_waitcnt vmcnt(3)
    buffer_load_dwordx4 v[92:95], v1, s[32:35], s46 offen offset:1024 nt
    s_waitcnt vmcnt(3)
    buffer_load_dwordx4 v[96:99], v1, s[32:35], s46 offen offset:2048 nt
    s_waitcnt vmcnt(3)
    buffer_load_dwordx4 v[100:103], v1, s[32:35], s46 offen offset:3072 nt
    s_waitcnt vmcnt(3)
    buffer_load_dwordx4 v[104:107], v2, s[36:39], 0 offen offset:0 nt
    s_waitcnt vmcnt(3)
    buffer_load_dwordx4 v[108:111], v2, s[36:39], 0 offen offset:1024 nt
    s_waitcnt vmcnt(3)
    buffer_load_dwordx4 v[112:115], v2, s[36:39], 0 offen offset:2048 nt
    s_waitcnt vmcnt(3)
    buffer_load_dwordx4 v[116:119], v2, s[36:39], 0 offen offset:3072 nt
    buffer_load_dwordx4 v[120:123], v2, s[36:39], s44 offen offset:0 nt
    buffer_load_dwordx4 v[124:127], v2, s[36:39], s44 offen offset:1024 nt
    buffer_load_dwordx4 v[128:131], v2, s[36:39], s44 offen offset:2048 nt
    s_mov_b32 s30, 400000
L_sp_1:
    ds_read_b32 v36, v35 offset:49760
    s_waitcnt lgkmcnt(0)
    v_readfirstlane_b32 s87, v36
    s_cmp_lg_u32 s87, 0
    s_cbranch_scc1 L_sd_2
    s_sleep 1
    s_sub_u32 s30, s30, 1
    s_cbranch_scc0 L_sp_1
L_sd_2:
    v_and_b32 v36, 8, v0
    v_cmp_eq_u32 vcc, 0, v36
    ds_read_b128 v[12:15], v34 offset:41472
    s_waitcnt lgkmcnt(0)
    v_cndmask_b32 v8, 0, v12, vcc
    v_cndmask_b32 v9, 0, v13, vcc
    v_cndmask_b32 v10, 0, v14, vcc
    v_cndmask_b32 v11, 0, v15, vcc
    v_cndmask_b32 v12, v12, 0, vcc
    v_cndmask_b32 v13, v13, 0, vcc
    v_cndmask_b32 v14, v14, 0, vcc
    v_cndmask_b32 v15, v15, 0, vcc
    s_waitcnt vmcnt(7)
    s_nop 1
    v_mfma_f32_16x16x32_bf16 v[16:19], v[40:43], v[8:11], 0
    v_mfma_f32_16x16x32_bf16 v[16:19], v[44:47], v[12:15], v[16:19]
    v_mfma_f32_16x16x32_bf16 v[20:23], v[48:51], v[8:11], 0
    v_mfma_f32_16x16x32_bf16 v[20:23], v[52:55], v[12:15], v[20:23]
    s_nop 5
    v_mul_f32_dpp v24, v16, v3 quad_perm:[0,0,0,0] row_mask:0xf bank_mask:0xf
    v_fmac_f32_dpp v24, v17, v3 quad_perm:[1,1,1,1] row_mask:0xf bank_mask:0xf
    v_fmac_f32_dpp v24, v18, v3 quad_perm:[2,2,2,2] row_mask:0xf bank_mask:0xf
    v_fmac_f32_dpp v24, v19, v3 quad_perm:[3,3,3,3] row_mask:0xf bank_mask:0xf
    v_cvt_pk_bf16_f32 v24, v24, v24
    v_and_b32 v24, 0xffff0000, v24
    v_mul_f32 v24, 0x3db504f3, v24
    v_cvt_pk_bf16_f32 v24, v24, v24
    v_and_b32 v24, 0xffff0000, v24
    v_mul_f32 v24, 0x3fb8aa3b, v24
    v_mfma_f32_16x16x32_bf16 v[16:19], v[56:59], v[8:11], 0
    v_mfma_f32_16x16x32_bf16 v[16:19], v[60:63], v[12:15], v[16:19]
    s_nop 5
    v_mul_f32_dpp v25, v20, v3 quad_perm:[0,0,0,0] row_mask:0xf bank_mask:0xf
    v_fmac_f32_dpp v25, v21, v3 quad_perm:[1,1,1,1] row_mask:0xf bank_mask:0xf
    v_fmac_f32_dpp v25, v22, v3 quad_perm:[2,2,2,2] row_mask:0xf bank_mask:0xf
    v_fmac_f32_dpp v25, v23, v3 quad_perm:[3,3,3,3] row_mask:0xf bank_mask:0xf
    v_cvt_pk_bf16_f32 v25, v25, v25
    v_and_b32 v25, 0xffff0000, v25
    v_mul_f32 v25, 0x3db504f3, v25
    v_cvt_pk_bf16_f32 v25, v25, v25
    v_and_b32 v25, 0xffff0000, v25
    v_mul_f32 v25, 0x3fb8aa3b, v25
    v_mfma_f32_16x16x32_bf16 v[20:23], v[64:67], v[8:11], 0
    v_mfma_f32_16x16x32_bf16 v[20:23], v[68:71], v[12:15], v[20:23]
    s_nop 5
    v_mul_f32_dpp v26, v16, v3 quad_perm:[0,0,0,0] row_mask:0xf bank_mask:0xf
    v_fmac_f32_dpp v26, v17, v3 quad_perm:[1,1,1,1] row_mask:0xf bank_mask:0xf
    v_fmac_f32_dpp v26, v18, v3 quad_perm:[2,2,2,2] row_mask:0xf bank_mask:0xf
    v_fmac_f32_dpp v26, v19, v3 quad_perm:[3,3,3,3] row_mask:0xf bank_mask:0xf
    v_cvt_pk_bf16_f32 v26, v26, v26
    v_and_b32 v26, 0xffff0000, v26
    v_mul_f32 v26, 0x3db504f3, v26
    v_cvt_pk_bf16_f32 v26, v26, v26
    v_and_b32 v26, 0xffff0000, v26
    v_mul_f32 v26, 0x3fb8aa3b, v26
    v_mfma_f32_16x16x32_bf16 v[16:19], v[72:75], v[8:11], 0
    v_mfma_f32_16x16x32_bf16 v[16:19], v[76:79], v[12:15], v[16:19]
    s_nop 5
    v_mul_f32_dpp v27, v20, v3 quad_perm:[0,0,0,0] row_mask:0xf bank_mask:0xf
    v_fmac_f32_dpp v27, v21, v3 quad_perm:[1,1,1,1] row_mask:0xf bank_mask:0xf
    v_fmac_f32_dpp v27, v22, v3 quad_perm:[2,2,2,2] row_mask:0xf bank_mask:0xf
    v_fmac_f32_dpp v27, v23, v3 quad_perm:[3,3,3,3] row_mask:0xf bank_mask:0xf
    v_cvt_pk_bf16_f32 v27, v27, v27
    v_and_b32 v27, 0xffff0000, v27
    v_mul_f32 v27, 0x3db504f3, v27
    v_cvt_pk_bf16_f32 v27, v27, v27
    v_and_b32 v27, 0xffff0000, v27
    v_mul_f32 v27, 0x3fb8aa3b, v27
    v_mfma_f32_16x16x32_bf16 v[20:23], v[80:83], v[8:11], 0
    v_mfma_f32_16x16x32_bf16 v[20:23], v[84:87], v[12:15], v[20:23]
    s_nop 5
    v_mul_f32_dpp v28, v16, v3 quad_perm:[0,0,0,0] row_mask:0xf bank_mask:0xf
    v_fmac_f32_dpp v28, v17, v3 quad_perm:[1,1,1,1] row_mask:0xf bank_mask:0xf
    v_fmac_f32_dpp v28, v18, v3 quad_perm:[2,2,2,2] row_mask:0xf bank_mask:0xf
    v_fmac_f32_dpp v28, v19, v3 quad_perm:[3,3,3,3] row_mask:0xf bank_mask:0xf
    v_cvt_pk_bf16_f32 v28, v28, v28
    v_and_b32 v28, 0xffff0000, v28
    v_mul_f32 v28, 0x3db504f3, v28
    v_cvt_pk_bf16_f32 v28, v28, v28
    v_and_b32 v28, 0xffff0000, v28
    v_mul_f32 v28, 0x3fb8aa3b, v28
    v_mfma_f32_16x16x32_bf16 v[16:19], v[88:91], v[8:11], 0
    v_mfma_f32_16x16x32_bf16 v[16:19], v[92:95], v[12:15], v[16:19]
    s_nop 5
    v_mul_f32_dpp v29, v20, v3 quad_perm:[0,0,0,0] row_mask:0xf bank_mask:0xf
    v_fmac_f32_dpp v29, v21, v3 quad_perm:[1,1,1,1] row_mask:0xf bank_mask:0xf
    v_fmac_f32_dpp v29, v22, v3 quad_perm:[2,2,2,2] row_mask:0xf bank_mask:0xf
    v_fmac_f32_dpp v29, v23, v3 quad_perm:[3,3,3,3] row_mask:0xf bank_mask:0xf
    v_cvt_pk_bf16_f32 v29, v29, v29
    v_and_b32 v29, 0xffff0000, v29
    v_mul_f32 v29, 0x3db504f3, v29
    v_cvt_pk_bf16_f32 v29, v29, v29
    v_and_b32 v29, 0xffff0000, v29
    v_mul_f32 v29, 0x3fb8aa3b, v29
    v_mfma_f32_16x16x32_bf16 v[20:23], v[96:99], v[8:11], 0
    v_mfma_f32_16x16x32_bf16 v[20:23], v[100:103], v[12:15], v[20:23]
    s_nop 5
    v_mul_f32_dpp v30, v16, v3 quad_perm:[0,0,0,0] row_mask:0xf bank_mask:0xf
    v_fmac_f32_dpp v30, v17, v3 quad_perm:[1,1,1,1] row_mask:0xf bank_mask:0xf
    v_fmac_f32_dpp v30, v18, v3 quad_perm:[2,2,2,2] row_mask:0xf bank_mask:0xf
    v_fmac_f32_dpp v30, v19, v3 quad_perm:[3,3,3,3] row_mask:0xf bank_mask:0xf
    v_cvt_pk_bf16_f32 v30, v30, v30
    v_and_b32 v30, 0xffff0000, v30
    v_mul_f32 v30, 0x3db504f3, v30
    v_cvt_pk_bf16_f32 v30, v30, v30
    v_and_b32 v30, 0xffff0000, v30
    v_mul_f32 v30, 0x3fb8aa3b, v30
    s_nop 7
    v_mul_f32_dpp v31, v20, v3 quad_perm:[0,0,0,0] row_mask:0xf bank_mask:0xf
    v_fmac_f32_dpp v31, v21, v3 quad_perm:[1,1,1,1] row_mask:0xf bank_mask:0xf
    v_fmac_f32_dpp v31, v22, v3 quad_perm:[2,2,2,2] row_mask:0xf bank_mask:0xf
    v_fmac_f32_dpp v31, v23, v3 quad_perm:[3,3,3,3] row_mask:0xf bank_mask:0xf
    v_cvt_pk_bf16_f32 v31, v31, v31
    v_and_b32 v31, 0xffff0000, v31
    v_mul_f32 v31, 0x3db504f3, v31
    v_cvt_pk_bf16_f32 v31, v31, v31
    v_and_b32 v31, 0xffff0000, v31
    v_mul_f32 v31, 0x3fb8aa3b, v31
    v_max3_f32 v32, v24, v25, v26
    v_max3_f32 v32, v32, v27, v28
    v_max3_f32 v32, v32, v29, v30
    v_max_f32 v32, v32, v31
    s_nop 1
    v_max_f32_dpp v32, v32, v32 row_ror:8 row_mask:0xf bank_mask:0xf
    v_mov_b32 v34, v32
    s_nop 1
    v_permlane16_swap_b32 v32, v34
    s_nop 0
    v_max_f32 v32, v32, v34
    v_mov_b32 v34, v32
    s_nop 1
    v_permlane32_swap_b32 v32, v34
    s_nop 0
    v_max_f32 v32, v32, v34
    s_waitcnt vmcnt(5)
    buffer_load_dwordx4 v[132:135], v2, s[36:39], s44 offen offset:3072 nt
    v_sub_f32 v24, v24, v32
    v_sub_f32 v25, v25, v32
    v_sub_f32 v26, v26, v32
    v_sub_f32 v27, v27, v32
    v_sub_f32 v28, v28, v32
    v_sub_f32 v29, v29, v32
    v_sub_f32 v30, v30, v32
    v_sub_f32 v31, v31, v32
    v_exp_f32 v24, v24
    v_exp_f32 v25, v25
    v_exp_f32 v26, v26
    v_exp_f32 v27, v27
    v_exp_f32 v28, v28
    v_exp_f32 v29, v29
    v_exp_f32 v30, v30
    v_exp_f32 v31, v31
    v_add_f32 v33, v24, v25
    v_add_f32 v33, v33, v26
    v_add_f32 v33, v33, v27
    v_add_f32 v33, v33, v28
    v_add_f32 v33, v33, v29
    v_add_f32 v33, v33, v30
    v_add_f32 v33, v33, v31
    v_cvt_pk_bf16_f32 v24, v24, v24
    v_cvt_pk_bf16_f32 v25, v25, v25
    v_cvt_pk_bf16_f32 v26, v26, v26
    v_cvt_pk_bf16_f32 v27, v27, v27
    v_cvt_pk_bf16_f32 v28, v28, v28
    v_cvt_pk_bf16_f32 v29, v29, v29
    v_cvt_pk_bf16_f32 v30, v30, v30
    v_cvt_pk_bf16_f32 v31, v31, v31
    v_add_f32_dpp v33, v33, v33 row_ror:8 row_mask:0xf bank_mask:0xf
    v_mov_b32 v34, v33
    s_nop 1
    v_permlane16_swap_b32 v33, v34
    s_nop 0
    v_add_f32 v33, v33, v34
    v_mov_b32 v34, v33
    s_nop 1
    v_permlane32_swap_b32 v33, v34
    s_nop 0
    v_add_f32 v33, v33, v34
    v_bfe_u32 v34, v0, 2, 1
    v_lshlrev_b32 v34, 5, v34
    s_lshl_b32 s83, s82, 2
    v_add_u32 v34, s83, v34
    ds_write_b32 v34, v32 offset:49056
    ds_write_b32 v34, v33 offset:49120
    v_mov_b32 v34, 1
    s_mov_b64 exec, 1
    ds_add_u32 v35, v34 offset:49776
    s_mov_b64 exec, -1
    s_waitcnt vmcnt(3)
    buffer_load_dwordx4 v[136:139], v2, s[36:39], s45 offen offset:0 nt
    v_and_b32 v40, v24, v4
    v_and_b32 v41, v24, v5
    v_and_b32_dpp v42, v24, v6 row_ror:8 row_mask:0xf bank_mask:0xf
    v_and_b32_dpp v43, v24, v7 row_ror:8 row_mask:0xf bank_mask:0xf
    v_and_b32_dpp v44, v24, v4 row_ror:8 row_mask:0xf bank_mask:0xf
    v_and_b32_dpp v45, v24, v5 row_ror:8 row_mask:0xf bank_mask:0xf
    v_and_b32 v46, v24, v6
    v_and_b32 v47, v24, v7
    v_and_b32 v48, v25, v4
    v_and_b32 v49, v25, v5
    v_and_b32_dpp v50, v25, v6 row_ror:8 row_mask:0xf bank_mask:0xf
    v_and_b32_dpp v51, v25, v7 row_ror:8 row_mask:0xf bank_mask:0xf
    v_and_b32_dpp v52, v25, v4 row_ror:8 row_mask:0xf bank_mask:0xf
    v_and_b32_dpp v53, v25, v5 row_ror:8 row_mask:0xf bank_mask:0xf
    v_and_b32 v54, v25, v6
    v_and_b32 v55, v25, v7
    v_mfma_f32_16x16x32_bf16 v[16:19], v[40:43], v[104:107], 0
    v_mfma_f32_16x16x32_bf16 v[16:19], v[44:47], v[108:111], v[16:19]
    s_waitcnt vmcnt(3)
    buffer_load_dwordx4 v[140:143], v2, s[36:39], s45 offen offset:1024 nt
    v_and_b32 v56, v26, v4
    v_and_b32 v57, v26, v5
    v_and_b32_dpp v58, v26, v6 row_ror:8 row_mask:0xf bank_mask:0xf
    v_and_b32_dpp v59, v26, v7 row_ror:8 row_mask:0xf bank_mask:0xf
    v_and_b32_dpp v60, v26, v4 row_ror:8 row_mask:0xf bank_mask:0xf
    v_and_b32_dpp v61, v26, v5 row_ror:8 row_mask:0xf bank_mask:0xf
    v_and_b32 v62, v26, v6
    v_and_b32 v63, v26, v7
    v_and_b32 v64, v27, v4
    v_and_b32 v65, v27, v5
    v_and_b32_dpp v66, v27, v6 row_ror:8 row_mask:0xf bank_mask:0xf
    v_and_b32_dpp v67, v27, v7 row_ror:8 row_mask:0xf bank_mask:0xf
    v_and_b32_dpp v68, v27, v4 row_ror:8 row_mask:0xf bank_mask:0xf
    v_and_b32_dpp v69, v27, v5 row_ror:8 row_mask:0xf bank_mask:0xf
    v_and_b32 v70, v27, v6
    v_and_b32 v71, v27, v7
    v_mfma_f32_16x16x32_bf16 v[16:19], v[48:51], v[112:115], v[16:19]
    v_mfma_f32_16x16x32_bf16 v[16:19], v[52:55], v[116:119], v[16:19]
    v_mfma_f32_16x16x32_bf16 v[16:19], v[56:59], v[120:123], v[16:19]
    v_mfma_f32_16x16x32_bf16 v[16:19], v[60:63], v[124:127], v[16:19]
    s_waitcnt vmcnt(3)
    buffer_load_dwordx4 v[144:147], v2, s[36:39], s45 offen offset:2048 nt
    v_and_b32 v72, v28, v4
    v_and_b32 v73, v28, v5
    v_and_b32_dpp v74, v28, v6 row_ror:8 row_mask:0xf bank_mask:0xf
    v_and_b32_dpp v75, v28, v7 row_ror:8 row_mask:0xf bank_mask:0xf
    v_and_b32_dpp v76, v28, v4 row_ror:8 row_mask:0xf bank_mask:0xf
    v_and_b32_dpp v77, v28, v5 row_ror:8 row_mask:0xf bank_mask:0xf
    v_and_b32 v78, v28, v6
    v_and_b32 v79, v28, v7
    v_and_b32 v80, v29, v4
    v_and_b32 v81, v29, v5
    v_and_b32_dpp v82, v29, v6 row_ror:8 row_mask:0xf bank_mask:0xf
    v_and_b32_dpp v83, v29, v7 row_ror:8 row_mask:0xf bank_mask:0xf
    v_and_b32_dpp v84, v29, v4 row_ror:8 row_mask:0xf bank_mask:0xf
    v_and_b32_dpp v85, v29, v5 row_ror:8 row_mask:0xf bank_mask:0xf
    v_and_b32 v86, v29, v6
    v_and_b32 v87, v29, v7
    v_mfma_f32_16x16x32_bf16 v[16:19], v[64:67], v[128:131], v[16:19]
    s_waitcnt vmcnt(3)
    buffer_load_dwordx4 v[148:151], v2, s[36:39], s45 offen offset:3072 nt
    v_and_b32 v88, v30, v4
    v_and_b32 v89, v30, v5
    v_and_b32_dpp v90, v30, v6 row_ror:8 row_mask:0xf bank_mask:0xf
    v_and_b32_dpp v91, v30, v7 row_ror:8 row_mask:0xf bank_mask:0xf
    v_and_b32_dpp v92, v30, v4 row_ror:8 row_mask:0xf bank_mask:0xf
    v_and_b32_dpp v93, v30, v5 row_ror:8 row_mask:0xf bank_mask:0xf
    v_and_b32 v94, v30, v6
    v_and_b32 v95, v30, v7
    v_and_b32 v96, v31, v4
    v_and_b32 v97, v31, v5
    v_and_b32_dpp v98, v31, v6 row_ror:8 row_mask:0xf bank_mask:0xf
    v_and_b32_dpp v99, v31, v7 row_ror:8 row_mask:0xf bank_mask:0xf
    v_and_b32_dpp v100, v31, v4 row_ror:8 row_mask:0xf bank_mask:0xf
    v_and_b32_dpp v101, v31, v5 row_ror:8 row_mask:0xf bank_mask:0xf
    v_and_b32 v102, v31, v6
    v_and_b32 v103, v31, v7
    v_mfma_f32_16x16x32_bf16 v[16:19], v[68:71], v[132:135], v[16:19]
    s_waitcnt vmcnt(3)
    buffer_load_dwordx4 v[152:155], v2, s[36:39], s46 offen offset:0 nt
    v_mfma_f32_16x16x32_bf16 v[16:19], v[72:75], v[136:139], v[16:19]
    s_waitcnt vmcnt(3)
    buffer_load_dwordx4 v[156:159], v2, s[36:39], s46 offen offset:1024 nt
    v_mfma_f32_16x16x32_bf16 v[16:19], v[76:79], v[140:143], v[16:19]
    s_waitcnt vmcnt(3)
    buffer_load_dwordx4 v[160:163], v2, s[36:39], s46 offen offset:2048 nt
    v_mfma_f32_16x16x32_bf16 v[16:19], v[80:83], v[144:147], v[16:19]
    s_waitcnt vmcnt(3)
    buffer_load_dwordx4 v[164:167], v2, s[36:39], s46 offen offset:3072 nt
    s_mov_b64 exec, 1
    ds_add_u32 v35, v34 offset:49780
    s_mov_b64 exec, -1
    v_mfma_f32_16x16x32_bf16 v[16:19], v[84:87], v[148:151], v[16:19]
    s_mov_b32 s30, 400000
L_sp_3:
    ds_read_b32 v36, v35 offset:49776
    s_waitcnt lgkmcnt(0)
    v_readfirstlane_b32 s83, v36
    s_cmp_eq_u32 s83, 8
    s_cbranch_scc1 L_sd_4
    s_sub_u32 s30, s30, 1
    s_cbranch_scc0 L_sp_3
L_sd_4:
    v_bfe_u32 v33, v0, 4, 1
    v_lshlrev_b32 v33, 5, v33
    s_lshl_b32 s83, s82, 2
    v_add_u32 v36, s83, v33
    ds_read_b128 v[24:27], v33 offset:49056
    ds_read_b128 v[28:31], v33 offset:49072
    ds_read_b32 v32, v36 offset:49056
    v_lshlrev_b32 v36, 4, v0
    v_bfe_u32 v20, v0, 4, 1
    v_lshlrev_b32 v20, 9, v20
    v_and_b32 v21, 15, v0
    v_lshl_add_u32 v20, v21, 5, v20
    v_lshrrev_b32 v21, 5, v0
    v_lshl_add_u32 v20, v21, 4, v20
    s_lshl_b32 s83, s81, 10
    s_add_u32 s83, s83, 65536
    v_add_u32 v20, s83, v20
    v_mov_b32 v21, s100
    s_waitcnt lgkmcnt(0)
    v_max3_f32 v33, v24, v25, v26
    v_max3_f32 v33, v33, v27, v28
    v_max3_f32 v33, v33, v29, v30
    v_max_f32 v33, v33, v31
    v_sub_f32 v32, v32, v33
    v_exp_f32 v32, v32
    s_lshl_b32 s83, s82, 10
    v_add_u32 v33, s83, v36
    s_waitcnt vmcnt(3)
    v_mfma_f32_16x16x32_bf16 v[16:19], v[88:91], v[152:155], v[16:19]
    s_waitcnt vmcnt(2)
    v_mfma_f32_16x16x32_bf16 v[16:19], v[92:95], v[156:159], v[16:19]
    s_waitcnt vmcnt(1)
    v_mfma_f32_16x16x32_bf16 v[16:19], v[96:99], v[160:163], v[16:19]
    s_waitcnt vmcnt(0)
    v_mfma_f32_16x16x32_bf16 v[16:19], v[100:103], v[164:167], v[16:19]
    s_nop 7
    v_mul_f32 v16, v16, v32
    v_mul_f32 v17, v17, v32
    v_mul_f32 v18, v18, v32
    v_mul_f32 v19, v19, v32
    ds_write_b128 v33, v[16:19] offset:0
    s_mov_b64 exec, 1
    ds_add_rtn_u32 v34, v35, v34 offset:49764
    s_mov_b64 exec, -1
    s_waitcnt lgkmcnt(0)
    v_readfirstlane_b32 s83, v34
    s_cmp_lg_u32 s83, 7
    s_cbranch_scc1 L_nopub
    ds_read_b128 v[40:43], v36 offset:0
    ds_read_b128 v[44:47], v36 offset:1024
    ds_read_b128 v[48:51], v36 offset:2048
    ds_read_b128 v[52:55], v36 offset:3072
    ds_read_b128 v[56:59], v36 offset:4096
    ds_read_b128 v[60:63], v36 offset:5120
    ds_read_b128 v[64:67], v36 offset:6144
    ds_read_b128 v[68:71], v36 offset:7168
    s_waitcnt lgkmcnt(6)
    v_add_f32 v40, v40, v44
    v_add_f32 v41, v41, v45
    v_add_f32 v42, v42, v46
    v_add_f32 v43, v43, v47
    s_waitcnt lgkmcnt(5)
    v_add_f32 v40, v40, v48
    v_add_f32 v41, v41, v49
    v_add_f32 v42, v42, v50
    v_add_f32 v43, v43, v51
    s_waitcnt lgkmcnt(4)
    v_add_f32 v40, v40, v52
    v_add_f32 v41, v41, v53
    v_add_f32 v42, v42, v54
    v_add_f32 v43, v43, v55
    s_waitcnt lgkmcnt(3)
    v_add_f32 v40, v40, v56
    v_add_f32 v41, v41, v57
    v_add_f32 v42, v42, v58
    v_add_f32 v43, v43, v59
    s_waitcnt lgkmcnt(2)
    v_add_f32 v40, v40, v60
    v_add_f32 v41, v41, v61
    v_add_f32 v42, v42, v62
    v_add_f32 v43, v43, v63
    s_waitcnt lgkmcnt(1)
    v_add_f32 v40, v40, v64
    v_add_f32 v41, v41, v65
    v_add_f32 v42, v42, v66
    v_add_f32 v43, v43, v67
    s_waitcnt lgkmcnt(0)
    v_add_f32 v40, v40, v68
    v_add_f32 v41, v41, v69
    v_add_f32 v42, v42, v70
    v_add_f32 v43, v43, v71
    v_bfi_b32 v40, s101, v21, v40
    v_bfi_b32 v41, s101, v21, v41
    v_bfi_b32 v42, s101, v21, v42
    v_bfi_b32 v43, s101, v21, v43
    s_cmp_eq_u32 s87, 2
    s_cbranch_scc1 L_opub_l
    buffer_store_dwordx4 v[40:43], v20, s[40:43], 0 offen sc1
    s_branch L_opub_d
L_opub_l:
    buffer_store_dwordx4 v[40:43], v20, s[40:43], 0 offen
L_opub_d:
L_nopub:
    v_mov_b32 v6, 1
    v_mov_b32 v7, 0
    s_mov_b32 s72, 0
    s_cmp_eq_u32 s3, 4
    s_cbranch_scc1 L_cstage2
L_pstage:
    s_mov_b32 s30, 400000
L_sp_5:
    ds_read_b32 v16, v7 offset:49768
    s_waitcnt lgkmcnt(0)
    v_readfirstlane_b32 s83, v16
    s_cmp_eq_u32 s83, 4
    s_cbranch_scc1 L_sd_6
    s_sub_u32 s30, s30, 1
    s_cbranch_scc0 L_sp_5
L_sd_6:
    ds_read_b128 v[48:51], v37
    ds_read_b64_tr_b16 v[56:57], v38
    ds_read_b64_tr_b16 v[58:59], v38 offset:4608
    ds_read_b128 v[52:55], v37 offset:64
    ds_read_b64_tr_b16 v[60:61], v38 offset:9216
    ds_read_b64_tr_b16 v[62:63], v38 offset:13824
    s_waitcnt lgkmcnt(3)
    v_mfma_f32_16x16x32_bf16 v[16:19], v[56:59], v[48:51], 0
    s_waitcnt lgkmcnt(0)
    v_mfma_f32_16x16x32_bf16 v[16:19], v[60:63], v[52:55], v[16:19]
    s_mov_b32 exec_lo, 0x000f000f
    s_mov_b32 exec_hi, 0x000f000f
    s_nop 5
    v_bfi_b32 v16, s101, v21, v16
    v_bfi_b32 v17, s101, v21, v17
    v_bfi_b32 v18, s101, v21, v18
    v_bfi_b32 v19, s101, v21, v19
    buffer_store_dwordx4 v[16:19], v39, s[40:43], 0 offen sc1
    s_mov_b64 exec, 1
    ds_add_u32 v7, v6 offset:49788
    s_mov_b64 exec, -1
    s_mov_b64 exec, -1
    s_branch L_fin
L_service:
    s_setprio 3
    s_mul_i32 s83, s3, 1152
    v_lshl_add_u32 v1, v0, 1, s83
    v_lshrrev_b32 v4, 3, v0
    v_lshlrev_b32 v4, 13, v4
    v_and_b32 v5, 7, v0
    v_lshl_add_u32 v4, v5, 4, v4
    s_mul_i32 s84, s78, 1179648
    s_lshl_b32 s85, s76, 9
    s_add_u32 s84, s84, s85
    s_lshl_b32 s85, s79, 7
    s_add_u32 s84, s84, s85
    v_add_u32 v4, s84, v4
    s_lshl_b32 s84, s3, 10
    s_lshl_b32 s85, s3, 16
    v_mov_b32 v6, 0
    v_mov_b32 v7, 0
    v_mov_b32 v8, 0
    v_mov_b32 v9, 0
    ds_write_b128 v6, v[6:9] offset:49760
    ds_write_b128 v6, v[6:9] offset:49776
    s_waitcnt lgkmcnt(0)
    s_mov_b32 s44, s4
    s_mov_b32 s45, s5
    s_mov_b32 s46, 0x1200
    s_mov_b32 s47, 0x20000
    s_mov_b32 s48, s10
    s_mov_b32 s49, s11
    s_mov_b32 s50, 0x480000
    s_mov_b32 s51, 0x20000
    buffer_load_ushort v10, v1, s[44:47], 0 offen offset:0
    buffer_load_ushort v11, v1, s[44:47], 0 offen offset:128
    buffer_load_ushort v12, v1, s[44:47], 0 offen offset:256
    buffer_load_ushort v13, v1, s[44:47], 0 offen offset:384
    buffer_load_ushort v14, v1, s[44:47], 0 offen offset:512
    buffer_load_ushort v15, v1, s[44:47], 0 offen offset:640
    buffer_load_ushort v16, v1, s[44:47], 0 offen offset:768
    buffer_load_ushort v17, v1, s[44:47], 0 offen offset:896
    buffer_load_ushort v18, v1, s[44:47], 0 offen offset:1024
    s_add_u32 m0, s84, 0
    s_add_u32 s86, s85, 0
    buffer_load_dwordx4 v4, s[48:51], s86 offen nt lds
    s_add_u32 m0, s84, 4096
    s_add_u32 s86, s85, 262144
    buffer_load_dwordx4 v4, s[48:51], s86 offen nt lds
    s_add_u32 m0, s84, 8192
    s_add_u32 s86, s85, 524288
    buffer_load_dwordx4 v4, s[48:51], s86 offen nt lds
    s_add_u32 m0, s84, 12288
    s_add_u32 s86, s85, 786432
    buffer_load_dwordx4 v4, s[48:51], s86 offen nt lds
    s_cmp_ge_u32 s3, 2
    s_cbranch_scc1 L_nodma
    s_add_u32 m0, s84, 16384
    s_add_u32 s86, s85, 1048576
    buffer_load_dwordx4 v4, s[48:51], s86 offen nt lds
    s_branch L_dmadone
L_nodma:
    s_cmp_eq_u32 s3, 2
    s_cselect_b32 s36, s8, s12
    s_cselect_b32 s37, s9, s13
    s_mov_b32 s38, 4718592
    s_cselect_b32 s38, 0x8000000, s38
    s_mov_b32 s39, 0x20000
    s_lshl_b32 s84, s78, 4
    s_add_u32 s84, s84, s76
    s_lshl_b32 s84, s84, 21
    s_add_u32 s84, s84, 0x180000
    s_lshr_b32 s85, s81, 2
    s_mul_i32 s85, s85, 73728
    s_cmp_eq_u32 s3, 2
    s_cselect_b32 s84, s84, s85
    buffer_load_dword v149, v6, s[36:39], s84 offen nt
L_dmadone:
    s_mov_b32 s40, s28
    s_mov_b32 s41, s29
    s_mov_b32 s42, 0x20000000
    s_mov_b32 s43, 0x20000
    s_load_dword s80, s[28:29], 0
    s_barrier
    s_mov_b32 s56, s16
    s_mov_b32 s57, s17
    s_mov_b32 s58, 0x2400
    s_mov_b32 s59, 0x20000
    s_mov_b32 s60, s18
    s_mov_b32 s61, s19
    s_mov_b32 s62, 0x2400
    s_mov_b32 s63, 0x20000
    s_mov_b32 s64, s20
    s_mov_b32 s65, s21
    s_mov_b32 s66, 0x2400
    s_mov_b32 s67, 0x20000
    s_movk_i32 s101, 0xff
    s_getreg_b32 s86, hwreg(HW_REG_XCC_ID)
    s_and_b32 s86, s86, 15
    s_lshl_b32 s86, s86, 8
    s_lshl_b32 s83, s76, 7
    s_add_u32 s83, s83, 1179648
    s_lshl_b32 s84, s77, 2
    s_add_u32 s84, s84, s83
    v_mov_b32 v9, s84
    v_and_b32 v22, 15, v0
    v_lshl_add_u32 v22, v22, 2, s83
    s_mov_b32 s87, 884736
    s_waitcnt lgkmcnt(0)
    s_and_b32 s100, s80, 0xff
    s_andn2_b32 s80, s80, 0xff
    s_cmp_eq_u32 s100, 0xff
    s_cselect_b32 s100, 0, s100
    s_add_u32 s100, s100, 1
    s_add_u32 s80, s80, 0x9E377900
    s_or_b32 s80, s80, s100
    s_andn2_b32 s85, s80, 0xf00
    s_or_b32 s86, s86, s85
    s_cmp_lg_u32 s3, 0
    s_cbranch_scc1 L_noxw
    v_mov_b32 v8, s86
    s_mov_b64 exec, 1
    buffer_store_dword v8, v9, s[40:43], 0 offen
    buffer_store_dword v8, v9, s[40:43], s87 offen sc1
    s_mov_b64 exec, -1
    s_waitcnt vmcnt(7)
    s_branch L_xok
L_noxw:
    s_waitcnt vmcnt(5)
L_xok:
    v_lshlrev_b32 v10, 16, v10
    v_lshlrev_b32 v11, 16, v11
    v_lshlrev_b32 v12, 16, v12
    v_lshlrev_b32 v13, 16, v13
    v_lshlrev_b32 v14, 16, v14
    v_lshlrev_b32 v15, 16, v15
    v_lshlrev_b32 v16, 16, v16
    v_lshlrev_b32 v17, 16, v17
    v_lshlrev_b32 v18, 16, v18
    v_add_f32 v6, v10, v11
    v_add_f32 v6, v6, v12
    v_add_f32 v6, v6, v13
    v_add_f32 v6, v6, v14
    v_add_f32 v6, v6, v15
    v_add_f32 v6, v6, v16
    v_add_f32 v6, v6, v17
    v_add_f32 v6, v6, v18
    s_nop 1
    v_add_f32_dpp v6, v6, v6 row_ror:8 row_mask:0xf bank_mask:0xf
    s_nop 1
    v_add_f32_dpp v6, v6, v6 row_ror:4 row_mask:0xf bank_mask:0xf
    s_nop 1
    v_add_f32_dpp v6, v6, v6 row_ror:2 row_mask:0xf bank_mask:0xf
    s_nop 1
    v_add_f32_dpp v6, v6, v6 row_ror:1 row_mask:0xf bank_mask:0xf
    v_mov_b32 v8, v6
    s_nop 1
    v_permlane16_swap_b32 v6, v8
    s_nop 0
    v_add_f32 v6, v6, v8
    v_mov_b32 v8, v6
    s_nop 1
    v_permlane32_swap_b32 v6, v8
    s_nop 0
    v_add_f32 v6, v6, v8
    v_mul_f32 v6, 0x3ae38e39, v6
    v_sub_f32 v8, v10, v6
    v_mul_f32 v7, v8, v8
    v_sub_f32 v8, v11, v6
    v_fmac_f32 v7, v8, v8
    v_sub_f32 v8, v12, v6
    v_fmac_f32 v7, v8, v8
    v_sub_f32 v8, v13, v6
    v_fmac_f32 v7, v8, v8
    v_sub_f32 v8, v14, v6
    v_fmac_f32 v7, v8, v8
    v_sub_f32 v8, v15, v6
    v_fmac_f32 v7, v8, v8
    v_sub_f32 v8, v16, v6
    v_fmac_f32 v7, v8, v8
    v_sub_f32 v8, v17, v6
    v_fmac_f32 v7, v8, v8
    v_sub_f32 v8, v18, v6
    v_fmac_f32 v7, v8, v8
    s_nop 1
    v_add_f32_dpp v7, v7, v7 row_ror:8 row_mask:0xf bank_mask:0xf
    s_nop 1
    v_add_f32_dpp v7, v7, v7 row_ror:4 row_mask:0xf bank_mask:0xf
    s_nop 1
    v_add_f32_dpp v7, v7, v7 row_ror:2 row_mask:0xf bank_mask:0xf
    s_nop 1
    v_add_f32_dpp v7, v7, v7 row_ror:1 row_mask:0xf bank_mask:0xf
    v_mov_b32 v8, v7
    s_nop 1
    v_permlane16_swap_b32 v7, v8
    s_nop 0
    v_add_f32 v7, v7, v8
    v_mov_b32 v8, v7
    s_nop 1
    v_permlane32_swap_b32 v7, v8
    s_nop 0
    v_add_f32 v7, v7, v8
    v_mul_f32 v7, 0x3ae38e39, v7
    v_cvt_pk_bf16_f32 v8, v6, v7
    v_lshlrev_b32 v6, 16, v8
    v_and_b32 v7, 0xffff0000, v8
    v_add_f32 v7, 0x3727c5ac, v7
    v_cvt_pk_bf16_f32 v7, v7, v7
    v_and_b32 v7, 0xffff0000, v7
    v_sqrt_f32 v7, v7
    s_nop 0
    v_cvt_pk_bf16_f32 v7, v7, v7
    v_and_b32 v7, 0xffff0000, v7
    v_rcp_f32 v7, v7
    v_sub_f32 v10, v10, v6
    v_sub_f32 v11, v11, v6
    v_sub_f32 v12, v12, v6
    v_sub_f32 v13, v13, v6
    v_sub_f32 v14, v14, v6
    v_sub_f32 v15, v15, v6
    v_sub_f32 v16, v16, v6
    v_sub_f32 v17, v17, v6
    v_sub_f32 v18, v18, v6
    v_cvt_pk_bf16_f32 v8, v10, v11
    v_lshlrev_b32 v10, 16, v8
    v_and_b32 v11, 0xffff0000, v8
    v_cvt_pk_bf16_f32 v8, v12, v13
    v_lshlrev_b32 v12, 16, v8
    v_and_b32 v13, 0xffff0000, v8
    v_cvt_pk_bf16_f32 v8, v14, v15
    v_lshlrev_b32 v14, 16, v8
    v_and_b32 v15, 0xffff0000, v8
    v_cvt_pk_bf16_f32 v8, v16, v17
    v_lshlrev_b32 v16, 16, v8
    v_and_b32 v17, 0xffff0000, v8
    v_cvt_pk_bf16_f32 v18, v18, v18
    v_and_b32 v18, 0xffff0000, v18
    v_mul_f32 v10, v10, v7
    v_mul_f32 v11, v11, v7
    v_mul_f32 v12, v12, v7
    v_mul_f32 v13, v13, v7
    v_mul_f32 v14, v14, v7
    v_mul_f32 v15, v15, v7
    v_mul_f32 v16, v16, v7
    v_mul_f32 v17, v17, v7
    v_mul_f32 v18, v18, v7
    v_cvt_pk_bf16_f32 v10, v10, v10
    v_cvt_pk_bf16_f32 v11, v11, v11
    v_cvt_pk_bf16_f32 v12, v12, v12
    v_cvt_pk_bf16_f32 v13, v13, v13
    v_cvt_pk_bf16_f32 v14, v14, v14
    v_cvt_pk_bf16_f32 v15, v15, v15
    v_cvt_pk_bf16_f32 v16, v16, v16
    v_cvt_pk_bf16_f32 v17, v17, v17
    v_cvt_pk_bf16_f32 v18, v18, v18
    ds_write_b16 v1, v10 offset:36864
    ds_write_b16 v1, v11 offset:36992
    ds_write_b16 v1, v12 offset:37120
    ds_write_b16 v1, v13 offset:37248
    ds_write_b16 v1, v14 offset:37376
    ds_write_b16 v1, v15 offset:37504
    ds_write_b16 v1, v16 offset:37632
    ds_write_b16 v1, v17 offset:37760
    ds_write_b16 v1, v18 offset:37888
    v_mov_b32 v6, 1
    v_mov_b32 v7, 0
    v_mov_b32 v21, s100
    v_and_b32 v10, 3, v0
    v_lshrrev_b32 v11, 4, v0
    v_mul_u32_u24 v12, 1152, v10
    v_lshl_add_u32 v12, v11, 3, v12
    s_mul_i32 s84, s78, 288
    v_add_u32 v12, s84, v12
    v_bfe_u32 v13, v0, 2, 2
    v_lshl_add_u32 v13, v11, 2, v13
    v_lshlrev_b32 v13, 7, v13
    v_lshl_add_u32 v13, v10, 3, v13
    s_lshl_b32 s84, s3, 5
    v_add_u32 v13, s84, v13
    v_lshlrev_b32 v14, 12, v10
    v_lshl_add_u32 v14, v11, 4, v14
    s_lshl_b32 s84, s76, 14
    s_lshl_b32 s85, s77, 8
    s_add_u32 s84, s84, s85
    s_lshl_b32 s85, s3, 6
    s_add_u32 s84, s84, s85
    s_add_u32 s84, s84, 327680
    v_add_u32 v14, s84, v14
    s_sub_u32 s82, s3, 1
    s_mul_i32 s84, s82, 3072
    v_lshl_add_u32 v2, v0, 4, s84
    s_cmp_lg_u32 s3, 0
    s_cbranch_scc1 L_dw1
    s_waitcnt vmcnt(2)
    s_branch L_dw2
L_dw1:
    s_waitcnt vmcnt(0)
L_dw2:
    s_mov_b64 exec, 1
    ds_add_u32 v7, v6 offset:49772
    s_mov_b64 exec, -1
    s_mov_b32 s30, 400000
L_sp_7:
    ds_read_b32 v8, v7 offset:49772
    s_waitcnt lgkmcnt(0)
    v_readfirstlane_b32 s84, v8
    s_cmp_eq_u32 s84, 4
    s_cbranch_scc1 L_sd_8
    s_sub_u32 s30, s30, 1
    s_cbranch_scc0 L_sp_7
L_sd_8:
    ds_read_b64 v[40:41], v12 offset:36864
    ds_read_b64_tr_b16 v[42:43], v13 offset:0
    ds_read_b64 v[44:45], v12 offset:36896
    ds_read_b64_tr_b16 v[46:47], v13 offset:2048
    ds_read_b64 v[48:49], v12 offset:36928
    ds_read_b64_tr_b16 v[50:51], v13 offset:4096
    ds_read_b64 v[52:53], v12 offset:36960
    ds_read_b64_tr_b16 v[54:55], v13 offset:6144
    ds_read_b64 v[56:57], v12 offset:36992
    ds_read_b64_tr_b16 v[58:59], v13 offset:8192
    ds_read_b64 v[60:61], v12 offset:37024
    ds_read_b64_tr_b16 v[62:63], v13 offset:10240
    s_waitcnt lgkmcnt(10)
    v_mfma_f32_16x16x16_bf16 v[16:19], v[42:43], v[40:41], 0
    ds_read_b64 v[64:65], v12 offset:37056
    ds_read_b64_tr_b16 v[66:67], v13 offset:12288
    s_waitcnt lgkmcnt(10)
    v_mfma_f32_16x16x16_bf16 v[16:19], v[46:47], v[44:45], v[16:19]
    ds_read_b64 v[68:69], v12 offset:37088
    ds_read_b64_tr_b16 v[70:71], v13 offset:14336
    s_waitcnt lgkmcnt(10)
    v_mfma_f32_16x16x16_bf16 v[16:19], v[50:51], v[48:49], v[16:19]
    ds_read_b64 v[72:73], v12 offset:37120
    ds_read_b64_tr_b16 v[74:75], v13 offset:16384
    s_waitcnt lgkmcnt(10)
    v_mfma_f32_16x16x16_bf16 v[16:19], v[54:55], v[52:53], v[16:19]
    s_waitcnt lgkmcnt(8)
    v_mfma_f32_16x16x16_bf16 v[16:19], v[58:59], v[56:57], v[16:19]
    s_waitcnt lgkmcnt(6)
    v_mfma_f32_16x16x16_bf16 v[16:19], v[62:63], v[60:61], v[16:19]
    s_waitcnt lgkmcnt(4)
    v_mfma_f32_16x16x16_bf16 v[16:19], v[66:67], v[64:65], v[16:19]
    s_waitcnt lgkmcnt(2)
    v_mfma_f32_16x16x16_bf16 v[16:19], v[70:71], v[68:69], v[16:19]
    s_waitcnt lgkmcnt(0)
    v_mfma_f32_16x16x16_bf16 v[16:19], v[74:75], v[72:73], v[16:19]
    s_lshr_b32 s83, s2, 6
    s_mul_i32 s83, s83, 1152
    s_mov_b32 exec_lo, 0x000f000f
    s_mov_b32 exec_hi, 0x000f000f
    s_nop 3
    v_bfi_b32 v16, s101, v21, v16
    v_bfi_b32 v17, s101, v21, v17
    v_bfi_b32 v18, s101, v21, v18
    v_bfi_b32 v19, s101, v21, v19
    buffer_store_dwordx4 v[16:19], v14, s[40:43], 0 offen
    buffer_store_dwordx4 v[16:19], v14, s[40:43], s87 offen sc1
    s_mov_b64 exec, -1
    s_cmp_eq_u32 s3, 0
    s_cbranch_scc1 L_s0
    buffer_load_dwordx4 v[112:115], v2, s[56:59], 0 offen offset:0
    buffer_load_dwordx4 v[116:119], v2, s[56:59], 0 offen offset:1024
    buffer_load_dwordx4 v[120:123], v2, s[56:59], 0 offen offset:2048
    buffer_load_dwordx4 v[124:127], v2, s[60:63], 0 offen offset:0
    buffer_load_dwordx4 v[128:131], v2, s[60:63], 0 offen offset:1024
    buffer_load_dwordx4 v[132:135], v2, s[60:63], 0 offen offset:2048
    buffer_load_dwordx4 v[136:139], v2, s[64:67], 0 offen offset:0
    buffer_load_dwordx4 v[140:143], v2, s[64:67], 0 offen offset:1024
    buffer_load_dwordx4 v[144:147], v2, s[64:67], 0 offen offset:2048
    s_getpc_b64 s[84:85]
L_pc:
    s_sub_u32 s84, s84, L_pc-recurrent_scan__sliding_block_cached__mixer_token_mlp__decode_kernel
    s_subb_u32 s85, s85, 0
    s_lshl_b32 s86, s82, 12
    v_lshl_add_u32 v3, v0, 6, s86
    v_min_u32 v3, L_codeend-recurrent_scan__sliding_block_cached__mixer_token_mlp__decode_kernel-4, v3
    s_cmp_lg_u32 s77, 0
    s_cbranch_scc1 L_nowarm
    global_load_dword v148, v3, s[84:85]
L_nowarm:
    s_setprio 0
    v_lshl_add_u32 v1, v0, 1, s83
    ds_read_u16 v20, v1 offset:36864
    ds_read_u16 v21, v1 offset:36992
    ds_read_u16 v22, v1 offset:37120
    ds_read_u16 v23, v1 offset:37248
    ds_read_u16 v24, v1 offset:37376
    ds_read_u16 v25, v1 offset:37504
    ds_read_u16 v26, v1 offset:37632
    ds_read_u16 v27, v1 offset:37760
    ds_read_u16 v28, v1 offset:37888
    s_waitcnt lgkmcnt(0)
    v_lshlrev_b32 v20, 16, v20
    v_lshlrev_b32 v21, 16, v21
    v_lshlrev_b32 v22, 16, v22
    v_lshlrev_b32 v23, 16, v23
    v_lshlrev_b32 v24, 16, v24
    v_lshlrev_b32 v25, 16, v25
    v_lshlrev_b32 v26, 16, v26
    v_lshlrev_b32 v27, 16, v27
    v_lshlrev_b32 v28, 16, v28
    v_add_f32 v4, v20, v21
    v_add_f32 v4, v4, v22
    v_add_f32 v4, v4, v23
    v_add_f32 v4, v4, v24
    v_add_f32 v4, v4, v25
    v_add_f32 v4, v4, v26
    v_add_f32 v4, v4, v27
    v_add_f32 v4, v4, v28
    s_nop 1
    v_add_f32_dpp v4, v4, v4 row_ror:8 row_mask:0xf bank_mask:0xf
    s_nop 1
    v_add_f32_dpp v4, v4, v4 row_ror:4 row_mask:0xf bank_mask:0xf
    s_nop 1
    v_add_f32_dpp v4, v4, v4 row_ror:2 row_mask:0xf bank_mask:0xf
    s_nop 1
    v_add_f32_dpp v4, v4, v4 row_ror:1 row_mask:0xf bank_mask:0xf
    v_mov_b32 v8, v4
    s_nop 1
    v_permlane16_swap_b32 v4, v8
    s_nop 0
    v_add_f32 v4, v4, v8
    v_mov_b32 v8, v4
    s_nop 1
    v_permlane32_swap_b32 v4, v8
    s_nop 0
    v_add_f32 v4, v4, v8
    v_mul_f32 v4, 0x3ae38e39, v4
    v_sub_f32 v8, v20, v4
    v_mul_f32 v5, v8, v8
    v_sub_f32 v8, v21, v4
    v_fmac_f32 v5, v8, v8
    v_sub_f32 v8, v22, v4
    v_fmac_f32 v5, v8, v8
    v_sub_f32 v8, v23, v4
    v_fmac_f32 v5, v8, v8
    v_sub_f32 v8, v24, v4
    v_fmac_f32 v5, v8, v8
    v_sub_f32 v8, v25, v4
    v_fmac_f32 v5, v8, v8
    v_sub_f32 v8, v26, v4
    v_fmac_f32 v5, v8, v8
    v_sub_f32 v8, v27, v4
    v_fmac_f32 v5, v8, v8
    v_sub_f32 v8, v28, v4
    v_fmac_f32 v5, v8, v8
    s_nop 1
    v_add_f32_dpp v5, v5, v5 row_ror:8 row_mask:0xf bank_mask:0xf
    s_nop 1
    v_add_f32_dpp v5, v5, v5 row_ror:4 row_mask:0xf bank_mask:0xf
    s_nop 1
    v_add_f32_dpp v5, v5, v5 row_ror:2 row_mask:0xf bank_mask:0xf
    s_nop 1
    v_add_f32_dpp v5, v5, v5 row_ror:1 row_mask:0xf bank_mask:0xf
    v_mov_b32 v8, v5
    s_nop 1
    v_permlane16_swap_b32 v5, v8
    s_nop 0
    v_add_f32 v5, v5, v8
    v_mov_b32 v8, v5
    s_nop 1
    v_permlane32_swap_b32 v5, v8
    s_nop 0
    v_add_f32 v5, v5, v8
    v_mul_f32 v5, 0x3ae38e39, v5
    v_cvt_pk_bf16_f32 v8, v4, v5
    v_lshlrev_b32 v4, 16, v8
    v_and_b32 v5, 0xffff0000, v8
    v_add_f32 v5, 0x3727c5ac, v5
    v_cvt_pk_bf16_f32 v5, v5, v5
    v_and_b32 v5, 0xffff0000, v5
    v_sqrt_f32 v5, v5
    s_nop 0
    v_cvt_pk_bf16_f32 v5, v5, v5
    v_and_b32 v5, 0xffff0000, v5
    v_rcp_f32 v5, v5
    v_sub_f32 v20, v20, v4
    v_sub_f32 v21, v21, v4
    v_sub_f32 v22, v22, v4
    v_sub_f32 v23, v23, v4
    v_sub_f32 v24, v24, v4
    v_sub_f32 v25, v25, v4
    v_sub_f32 v26, v26, v4
    v_sub_f32 v27, v27, v4
    v_sub_f32 v28, v28, v4
    v_cvt_pk_bf16_f32 v8, v20, v21
    v_lshlrev_b32 v20, 16, v8
    v_and_b32 v21, 0xffff0000, v8
    v_cvt_pk_bf16_f32 v8, v22, v23
    v_lshlrev_b32 v22, 16, v8
    v_and_b32 v23, 0xffff0000, v8
    v_cvt_pk_bf16_f32 v8, v24, v25
    v_lshlrev_b32 v24, 16, v8
    v_and_b32 v25, 0xffff0000, v8
    v_cvt_pk_bf16_f32 v8, v26, v27
    v_lshlrev_b32 v26, 16, v8
    v_and_b32 v27, 0xffff0000, v8
    v_cvt_pk_bf16_f32 v28, v28, v28
    v_and_b32 v28, 0xffff0000, v28
    v_mul_f32 v20, v20, v5
    v_mul_f32 v21, v21, v5
    v_mul_f32 v22, v22, v5
    v_mul_f32 v23, v23, v5
    v_mul_f32 v24, v24, v5
    v_mul_f32 v25, v25, v5
    v_mul_f32 v26, v26, v5
    v_mul_f32 v27, v27, v5
    v_mul_f32 v28, v28, v5
    v_cvt_pk_bf16_f32 v8, v20, v21
    v_lshlrev_b32 v20, 16, v8
    v_and_b32 v21, 0xffff0000, v8
    v_cvt_pk_bf16_f32 v8, v22, v23
    v_lshlrev_b32 v22, 16, v8
    v_and_b32 v23, 0xffff0000, v8
    v_cvt_pk_bf16_f32 v8, v24, v25
    v_lshlrev_b32 v24, 16, v8
    v_and_b32 v25, 0xffff0000, v8
    v_cvt_pk_bf16_f32 v8, v26, v27
    v_lshlrev_b32 v26, 16, v8
    v_and_b32 v27, 0xffff0000, v8
    v_cvt_pk_bf16_f32 v28, v28, v28
    v_and_b32 v28, 0xffff0000, v28
    s_mul_i32 s84, s82, 2304
    s_add_u32 s84, s84, 41984
    v_lshl_add_u32 v3, v0, 2, s84
    ds_write_b32 v3, v20 offset:0
    ds_write_b32 v3, v21 offset:256
    ds_write_b32 v3, v22 offset:512
    ds_write_b32 v3, v23 offset:768
    ds_write_b32 v3, v24 offset:1024
    ds_write_b32 v3, v25 offset:1280
    ds_write_b32 v3, v26 offset:1536
    ds_write_b32 v3, v27 offset:1792
    ds_write_b32 v3, v28 offset:2048
    s_and_b32 s85, s2, 63
    s_mul_i32 s85, s85, 36
    s_add_u32 s84, s84, s85
    v_mov_b32 v3, s84
    s_lshl_b32 s84, s82, 2
    s_add_u32 s84, s84, 48896
    v_mov_b32 v2, s84
    ds_read_b32 v34, v3
    s_waitcnt vmcnt(0)
    v_lshlrev_b32 v40, 16, v112
    v_and_b32 v41, 0xffff0000, v112
    v_lshlrev_b32 v42, 16, v113
    v_and_b32 v43, 0xffff0000, v113
    v_lshlrev_b32 v44, 16, v114
    v_and_b32 v45, 0xffff0000, v114
    v_lshlrev_b32 v46, 16, v115
    v_and_b32 v47, 0xffff0000, v115
    v_lshlrev_b32 v48, 16, v116
    v_and_b32 v49, 0xffff0000, v116
    v_lshlrev_b32 v50, 16, v117
    v_and_b32 v51, 0xffff0000, v117
    v_lshlrev_b32 v52, 16, v118
    v_and_b32 v53, 0xffff0000, v118
    v_lshlrev_b32 v54, 16, v119
    v_and_b32 v55, 0xffff0000, v119
    v_lshlrev_b32 v56, 16, v120
    v_and_b32 v57, 0xffff0000, v120
    v_lshlrev_b32 v58, 16, v121
    v_and_b32 v59, 0xffff0000, v121
    v_lshlrev_b32 v60, 16, v122
    v_and_b32 v61, 0xffff0000, v122
    v_lshlrev_b32 v62, 16, v123
    v_and_b32 v63, 0xffff0000, v123
    v_lshlrev_b32 v64, 16, v124
    v_and_b32 v65, 0xffff0000, v124
    v_lshlrev_b32 v66, 16, v125
    v_and_b32 v67, 0xffff0000, v125
    v_lshlrev_b32 v68, 16, v126
    v_and_b32 v69, 0xffff0000, v126
    v_lshlrev_b32 v70, 16, v127
    v_and_b32 v71, 0xffff0000, v127
    v_lshlrev_b32 v72, 16, v128
    v_and_b32 v73, 0xffff0000, v128
    v_lshlrev_b32 v74, 16, v129
    v_and_b32 v75, 0xffff0000, v129
    v_lshlrev_b32 v76, 16, v130
    v_and_b32 v77, 0xffff0000, v130
    v_lshlrev_b32 v78, 16, v131
    v_and_b32 v79, 0xffff0000, v131
    v_lshlrev_b32 v80, 16, v132
    v_and_b32 v81, 0xffff0000, v132
    v_lshlrev_b32 v82, 16, v133
    v_and_b32 v83, 0xffff0000, v133
    v_lshlrev_b32 v84, 16, v134
    v_and_b32 v85, 0xffff0000, v134
    v_lshlrev_b32 v86, 16, v135
    v_and_b32 v87, 0xffff0000, v135
    v_lshlrev_b32 v88, 16, v136
    v_and_b32 v89, 0xffff0000, v136
    v_lshlrev_b32 v90, 16, v137
    v_and_b32 v91, 0xffff0000, v137
    v_lshlrev_b32 v92, 16, v138
    v_and_b32 v93, 0xffff0000, v138
    v_lshlrev_b32 v94, 16, v139
    v_and_b32 v95, 0xffff0000, v139
    v_lshlrev_b32 v96, 16, v140
    v_and_b32 v97, 0xffff0000, v140
    v_lshlrev_b32 v98, 16, v141
    v_and_b32 v99, 0xffff0000, v141
    v_lshlrev_b32 v100, 16, v142
    v_and_b32 v101, 0xffff0000, v142
    v_lshlrev_b32 v102, 16, v143
    v_and_b32 v103, 0xffff0000, v143
    v_lshlrev_b32 v104, 16, v144
    v_and_b32 v105, 0xffff0000, v144
    v_lshlrev_b32 v106, 16, v145
    v_and_b32 v107, 0xffff0000, v145
    v_lshlrev_b32 v108, 16, v146
    v_and_b32 v109, 0xffff0000, v146
    v_lshlrev_b32 v110, 16, v147
    v_and_b32 v111, 0xffff0000, v147
    v_mov_b32 v30, 0xbdd2d3e8
    v_mov_b32 v31, 0xbdd2d3e8
    v_mov_b32 v32, 0xc0135761
    v_mov_b32 v33, 0xc0135761
    v_mov_b32 v28, 1.0
    v_mov_b32 v29, 1.0
    s_mov_b32 s30, 9
L_gelu:
    s_waitcnt lgkmcnt(0)
    v_mov_b32 v36, v34
    v_add_u32 v3, 4, v3
    ds_read_b32 v34, v3
    v_pk_fma_f32 v[10:11], v[36:37], v[40:41], v[64:65] op_sel_hi:[0,1,1]
    v_pk_fma_f32 v[12:13], v[36:37], v[42:43], v[66:67] op_sel_hi:[0,1,1]
    v_pk_mul_f32 v[14:15], v[10:11], v[10:11]
    v_pk_mul_f32 v[16:17], v[12:13], v[12:13]
    v_pk_fma_f32 v[14:15], v[14:15], v[30:31], v[32:33]
    v_pk_fma_f32 v[16:17], v[16:17], v[30:31], v[32:33]
    v_pk_mul_f32 v[14:15], v[14:15], v[10:11]
    v_pk_mul_f32 v[16:17], v[16:17], v[12:13]
    v_exp_f32 v14, v14
    v_exp_f32 v15, v15
    v_exp_f32 v16, v16
    v_exp_f32 v17, v17
    v_pk_mul_f32 v[18:19], v[10:11], v[88:89]
    v_pk_mul_f32 v[20:21], v[12:13], v[90:91]
    v_pk_add_f32 v[14:15], v[14:15], v[28:29]
    v_pk_add_f32 v[16:17], v[16:17], v[28:29]
    v_rcp_f32 v14, v14
    v_rcp_f32 v15, v15
    v_rcp_f32 v16, v16
    v_rcp_f32 v17, v17
    v_pk_mul_f32 v[22:23], v[18:19], v[14:15]
    v_pk_mul_f32 v[24:25], v[20:21], v[16:17]
    v_pk_fma_f32 v[10:11], v[36:37], v[44:45], v[68:69] op_sel_hi:[0,1,1]
    v_pk_fma_f32 v[12:13], v[36:37], v[46:47], v[70:71] op_sel_hi:[0,1,1]
    v_pk_mul_f32 v[14:15], v[10:11], v[10:11]
    v_pk_mul_f32 v[16:17], v[12:13], v[12:13]
    v_pk_fma_f32 v[14:15], v[14:15], v[30:31], v[32:33]
    v_pk_fma_f32 v[16:17], v[16:17], v[30:31], v[32:33]
    v_pk_mul_f32 v[14:15], v[14:15], v[10:11]
    v_pk_mul_f32 v[16:17], v[16:17], v[12:13]
    v_exp_f32 v14, v14
    v_exp_f32 v15, v15
    v_exp_f32 v16, v16
    v_exp_f32 v17, v17
    v_pk_mul_f32 v[18:19], v[10:11], v[92:93]
    v_pk_mul_f32 v[20:21], v[12:13], v[94:95]
    v_pk_add_f32 v[14:15], v[14:15], v[28:29]
    v_pk_add_f32 v[16:17], v[16:17], v[28:29]
    v_rcp_f32 v14, v14
    v_rcp_f32 v15, v15
    v_rcp_f32 v16, v16
    v_rcp_f32 v17, v17
    v_pk_fma_f32 v[22:23], v[18:19], v[14:15], v[22:23]
    v_pk_fma_f32 v[24:25], v[20:21], v[16:17], v[24:25]
    v_pk_fma_f32 v[10:11], v[36:37], v[48:49], v[72:73] op_sel_hi:[0,1,1]
    v_pk_fma_f32 v[12:13], v[36:37], v[50:51], v[74:75] op_sel_hi:[0,1,1]
    v_pk_mul_f32 v[14:15], v[10:11], v[10:11]
    v_pk_mul_f32 v[16:17], v[12:13], v[12:13]
    v_pk_fma_f32 v[14:15], v[14:15], v[30:31], v[32:33]
    v_pk_fma_f32 v[16:17], v[16:17], v[30:31], v[32:33]
    v_pk_mul_f32 v[14:15], v[14:15], v[10:11]
    v_pk_mul_f32 v[16:17], v[16:17], v[12:13]
    v_exp_f32 v14, v14
    v_exp_f32 v15, v15
    v_exp_f32 v16, v16
    v_exp_f32 v17, v17
    v_pk_mul_f32 v[18:19], v[10:11], v[96:97]
    v_pk_mul_f32 v[20:21], v[12:13], v[98:99]
    v_pk_add_f32 v[14:15], v[14:15], v[28:29]
    v_pk_add_f32 v[16:17], v[16:17], v[28:29]
    v_rcp_f32 v14, v14
    v_rcp_f32 v15, v15
    v_rcp_f32 v16, v16
    v_rcp_f32 v17, v17
    v_pk_fma_f32 v[22:23], v[18:19], v[14:15], v[22:23]
    v_pk_fma_f32 v[24:25], v[20:21], v[16:17], v[24:25]
    v_pk_fma_f32 v[10:11], v[36:37], v[52:53], v[76:77] op_sel_hi:[0,1,1]
    v_pk_fma_f32 v[12:13], v[36:37], v[54:55], v[78:79] op_sel_hi:[0,1,1]
    v_pk_mul_f32 v[14:15], v[10:11], v[10:11]
    v_pk_mul_f32 v[16:17], v[12:13], v[12:13]
    v_pk_fma_f32 v[14:15], v[14:15], v[30:31], v[32:33]
    v_pk_fma_f32 v[16:17], v[16:17], v[30:31], v[32:33]
    v_pk_mul_f32 v[14:15], v[14:15], v[10:11]
    v_pk_mul_f32 v[16:17], v[16:17], v[12:13]
    v_exp_f32 v14, v14
    v_exp_f32 v15, v15
    v_exp_f32 v16, v16
    v_exp_f32 v17, v17
    v_pk_mul_f32 v[18:19], v[10:11], v[100:101]
    v_pk_mul_f32 v[20:21], v[12:13], v[102:103]
    v_pk_add_f32 v[14:15], v[14:15], v[28:29]
    v_pk_add_f32 v[16:17], v[16:17], v[28:29]
    v_rcp_f32 v14, v14
    v_rcp_f32 v15, v15
    v_rcp_f32 v16, v16
    v_rcp_f32 v17, v17
    v_pk_fma_f32 v[22:23], v[18:19], v[14:15], v[22:23]
    v_pk_fma_f32 v[24:25], v[20:21], v[16:17], v[24:25]
    v_pk_fma_f32 v[10:11], v[36:37], v[56:57], v[80:81] op_sel_hi:[0,1,1]
    v_pk_fma_f32 v[12:13], v[36:37], v[58:59], v[82:83] op_sel_hi:[0,1,1]
    v_pk_mul_f32 v[14:15], v[10:11], v[10:11]
    v_pk_mul_f32 v[16:17], v[12:13], v[12:13]
    v_pk_fma_f32 v[14:15], v[14:15], v[30:31], v[32:33]
    v_pk_fma_f32 v[16:17], v[16:17], v[30:31], v[32:33]
    v_pk_mul_f32 v[14:15], v[14:15], v[10:11]
    v_pk_mul_f32 v[16:17], v[16:17], v[12:13]
    v_exp_f32 v14, v14
    v_exp_f32 v15, v15
    v_exp_f32 v16, v16
    v_exp_f32 v17, v17
    v_pk_mul_f32 v[18:19], v[10:11], v[104:105]
    v_pk_mul_f32 v[20:21], v[12:13], v[106:107]
    v_pk_add_f32 v[14:15], v[14:15], v[28:29]
    v_pk_add_f32 v[16:17], v[16:17], v[28:29]
    v_rcp_f32 v14, v14
    v_rcp_f32 v15, v15
    v_rcp_f32 v16, v16
    v_rcp_f32 v17, v17
    v_pk_fma_f32 v[22:23], v[18:19], v[14:15], v[22:23]
    v_pk_fma_f32 v[24:25], v[20:21], v[16:17], v[24:25]
    v_pk_fma_f32 v[10:11], v[36:37], v[60:61], v[84:85] op_sel_hi:[0,1,1]
    v_pk_fma_f32 v[12:13], v[36:37], v[62:63], v[86:87] op_sel_hi:[0,1,1]
    v_pk_mul_f32 v[14:15], v[10:11], v[10:11]
    v_pk_mul_f32 v[16:17], v[12:13], v[12:13]
    v_pk_fma_f32 v[14:15], v[14:15], v[30:31], v[32:33]
    v_pk_fma_f32 v[16:17], v[16:17], v[30:31], v[32:33]
    v_pk_mul_f32 v[14:15], v[14:15], v[10:11]
    v_pk_mul_f32 v[16:17], v[16:17], v[12:13]
    v_exp_f32 v14, v14
    v_exp_f32 v15, v15
    v_exp_f32 v16, v16
    v_exp_f32 v17, v17
    v_pk_mul_f32 v[18:19], v[10:11], v[108:109]
    v_pk_mul_f32 v[20:21], v[12:13], v[110:111]
    v_pk_add_f32 v[14:15], v[14:15], v[28:29]
    v_pk_add_f32 v[16:17], v[16:17], v[28:29]
    v_rcp_f32 v14, v14
    v_rcp_f32 v15, v15
    v_rcp_f32 v16, v16
    v_rcp_f32 v17, v17
    v_pk_fma_f32 v[22:23], v[18:19], v[14:15], v[22:23]
    v_pk_fma_f32 v[24:25], v[20:21], v[16:17], v[24:25]
    v_pk_add_f32 v[22:23], v[22:23], v[24:25]
    v_add_f32 v22, v22, v23
    s_nop 1
    v_add_f32_dpp v22, v22, v22 row_ror:8 row_mask:0xf bank_mask:0xf
    s_nop 1
    v_add_f32_dpp v22, v22, v22 row_ror:4 row_mask:0xf bank_mask:0xf
    s_nop 1
    v_add_f32_dpp v22, v22, v22 row_ror:2 row_mask:0xf bank_mask:0xf
    s_nop 1
    v_add_f32_dpp v22, v22, v22 row_ror:1 row_mask:0xf bank_mask:0xf
    v_mov_b32 v23, v22
    s_nop 1
    v_permlane16_swap_b32 v22, v23
    s_nop 0
    v_add_f32 v22, v22, v23
    v_mov_b32 v23, v22
    s_nop 1
    v_permlane32_swap_b32 v22, v23
    s_nop 0
    v_add_f32 v22, v22, v23
    ds_write_b32 v2, v22
    v_add_u32 v2, 16, v2
    s_sub_u32 s30, s30, 1
    s_cmp_lg_u32 s30, 0
    s_cbranch_scc1 L_gelu
    s_mov_b64 exec, 1
    ds_add_u32 v7, v6 offset:49784
    s_mov_b64 exec, -1
    s_waitcnt lgkmcnt(0)
    s_setprio 3
    s_cmp_eq_u32 s3, 2
    s_cbranch_scc1 L_gpub
    s_branch L_cstage
L_gpub:
    s_mov_b32 s72, s22
    s_mov_b32 s73, s23
    s_mov_b32 s74, 0x2
    s_mov_b32 s75, 0x20000
    buffer_load_ushort v8, v7, s[72:75], 0 offen
    s_mul_i32 s84, s2, 72
    s_add_u32 s84, s84, 4096
    v_lshl_add_u32 v3, v0, 3, s84
    s_mov_b32 s30, 400000
L_sp_9:
    ds_read_b32 v22, v7 offset:49784
    s_waitcnt lgkmcnt(0)
    v_readfirstlane_b32 s84, v22
    s_cmp_eq_u32 s84, 3
    s_cbranch_scc1 L_sd_10
    s_sleep 1
    s_sub_u32 s30, s30, 1
    s_cbranch_scc0 L_sp_9
L_sd_10:
    v_lshlrev_b32 v22, 4, v0
    v_and_b32 v22, 0xff, v22
    ds_read_b128 v[40:43], v22 offset:48896
    s_waitcnt vmcnt(0) lgkmcnt(0)
    v_lshlrev_b32 v8, 16, v8
    v_add_f32 v40, v40, v41
    v_add_f32 v40, v40, v42
    v_cvt_pk_bf16_f32 v40, v40, v40
    v_and_b32 v40, 0xffff0000, v40
    v_add_f32 v40, v40, v8
    v_cvt_pk_bf16_f32 v40, v40, v40
    v_and_b32 v40, 0xffff0000, v40
    v_mul_f32 v41, 0xbfb8aa3b, v40
    v_exp_f32 v41, v41
    s_nop 0
    v_add_f32 v41, 1.0, v41
    v_rcp_f32 v41, v41
    s_nop 0
    v_mul_f32 v40, v40, v41
    v_cvt_pk_bf16_f32 v40, v40, v40
    v_and_b32 v40, 0xffff0000, v40
    v_mov_b32 v41, s80
    s_mov_b64 exec, 0x1ff
    buffer_store_dwordx2 v[40:41], v3, s[40:43], 0 offen sc1
    s_mov_b64 exec, -1
L_cstage:
    s_mov_b32 s31, 8
    v_and_b32 v12, 3, v0
    v_lshrrev_b32 v39, 4, v0
    v_lshlrev_b32 v37, 7, v12
    v_lshl_add_u32 v37, v39, 4, v37
    v_add_u32 v37, 49184, v37
    v_bfe_u32 v38, v0, 2, 2
    v_lshl_add_u32 v38, v39, 2, v38
    v_mul_u32_u24 v38, 288, v38
    v_lshl_add_u32 v38, v12, 3, v38
    s_lshl_b32 s83, s31, 5
    s_add_u32 s83, s83, 18432
    v_add_u32 v38, s83, v38
    v_lshlrev_b32 v39, 4, v39
    v_mul_u32_u24 v12, 147456, v12
    v_add_u32 v39, v39, v12
    s_mul_i32 s83, s79, 9
    s_add_u32 s83, s83, s31
    s_lshl_b32 s83, s83, 12
    s_lshr_b32 s84, s81, 2
    s_lshl_b32 s84, s84, 6
    s_add_u32 s83, s83, s84
    s_add_u32 s83, s83, 589824
    v_add_u32 v39, s83, v39
    v_mov_b32 v21, s100
    s_mov_b32 s72, s3
L_cstage2:
    v_lshrrev_b32 v11, 4, v0
    v_and_b32 v10, 15, v0
    s_lshl_b32 s83, s76, 2
    s_add_u32 s83, s83, s72
    s_lshl_b32 s84, s83, 9
    s_lshr_b32 s85, s78, 1
    s_lshl_b32 s85, s85, 4
    s_add_u32 s84, s84, s85
    s_add_u32 s84, s84, 32768
    v_lshl_add_u32 v14, v11, 7, s84
    s_lshl_b32 s84, s83, 12
    s_lshl_b32 s85, s78, 8
    s_add_u32 s84, s84, s85
    s_add_u32 s84, s84, 65536
    v_lshl_add_u32 v15, v10, 4, s84
    v_lshl_add_u32 v15, v11, 10, v15
    v_and_b32 v12, 8, v0
    v_lshlrev_b32 v12, 3, v12
    v_and_b32 v13, 3, v0
    v_lshl_add_u32 v12, v13, 4, v12
    v_bfe_u32 v13, v0, 2, 1
    v_lshl_add_u32 v12, v13, 3, v12
    v_bfe_u32 v13, v0, 4, 1
    v_lshl_add_u32 v12, v13, 2, v12
    v_lshrrev_b32 v13, 5, v0
    v_lshl_add_u32 v12, v13, 1, v12
    s_lshl_b32 s84, s72, 7
    v_add_u32 v12, s84, v12
    s_mov_b32 s30, 400000
L_sp_11:
    ds_read_b32 v16, v7 offset:49776
    s_waitcnt lgkmcnt(0)
    v_readfirstlane_b32 s84, v16
    s_cmp_eq_u32 s84, 8
    s_cbranch_scc1 L_sd_12
    s_sleep 4
    s_sub_u32 s30, s30, 1
    s_cbranch_scc0 L_sp_11
L_sd_12:
    s_mov_b32 s30, 200000
L_stpoll:
    buffer_load_dwordx4 v[44:47], v14, s[40:43], 0 offen sc1
    s_waitcnt vmcnt(0)
    v_xor_b32 v45, s80, v45
    v_xor_b32 v47, s80, v47
    v_or_b32 v45, v45, v47
    v_cmp_ne_u32 vcc, 0, v45
    s_sub_u32 s30, s30, 1
    s_cbranch_scc1 L_stdone
    s_cbranch_vccnz L_stpoll
L_stdone:
    v_mov_b32 v45, v44
    v_mov_b32 v47, v45
    s_nop 1
    v_permlane16_swap_b32 v45, v47
    s_nop 0
    v_max_f32 v45, v45, v47
    v_mov_b32 v47, v45
    s_nop 1
    v_permlane32_swap_b32 v45, v47
    s_nop 0
    v_max_f32 v45, v45, v47
    v_sub_f32 v44, v44, v45
    v_exp_f32 v44, v44
    s_nop 0
    v_mul_f32 v46, v44, v46
    v_mov_b32 v47, v46
    s_nop 1
    v_permlane16_swap_b32 v46, v47
    s_nop 0
    v_add_f32 v46, v46, v47
    v_mov_b32 v47, v46
    s_nop 1
    v_permlane32_swap_b32 v46, v47
    s_nop 0
    v_add_f32 v46, v46, v47
    v_rcp_f32 v46, v46
    s_nop 0
    v_mul_f32 v24, v44, v46
    s_cmp_lg_u32 s3, 1
    s_cbranch_scc1 L_nowo
    s_mov_b32 s52, s12
    s_mov_b32 s53, s13
    s_mov_b32 s54, 0x480000
    s_mov_b32 s55, 0x20000
    v_mul_u32_u24 v26, 57, v0
    v_lshrrev_b32 v26, 10, v26
    v_mul_u32_u24 v27, 18, v26
    v_sub_u32 v27, v0, v27
    v_mul_u32_u24 v100, 1152, v26
    v_lshl_add_u32 v100, v27, 4, v100
    s_lshl_b32 s84, s76, 2
    s_add_u32 s84, s84, s78
    s_mul_i32 s84, s84, 73728
    s_mul_i32 s85, s79, 288
    s_add_u32 s84, s84, s85
    v_add_u32 v100, s84, v100
    v_mov_b32 v28, 3616
    v_mov_b32 v29, 4480
    v_add_u32 v27, 10, v27
    v_cmp_le_u32 vcc, 18, v27
    v_subrev_u32 v26, 18, v27
    s_nop 0
    v_cndmask_b32 v27, v27, v26, vcc
    v_cndmask_b32 v26, v28, v29, vcc
    v_add_u32 v101, v100, v26
    v_add_u32 v27, 10, v27
    v_cmp_le_u32 vcc, 18, v27
    v_subrev_u32 v26, 18, v27
    s_nop 0
    v_cndmask_b32 v27, v27, v26, vcc
    v_cndmask_b32 v26, v28, v29, vcc
    v_add_u32 v102, v101, v26
    v_add_u32 v27, 10, v27
    v_cmp_le_u32 vcc, 18, v27
    v_subrev_u32 v26, 18, v27
    s_nop 0
    v_cndmask_b32 v27, v27, v26, vcc
    v_cndmask_b32 v26, v28, v29, vcc
    v_add_u32 v103, v102, v26
    v_add_u32 v27, 10, v27
    v_cmp_le_u32 vcc, 18, v27
    v_subrev_u32 v26, 18, v27
    s_nop 0
    v_cndmask_b32 v27, v27, v26, vcc
    v_cndmask_b32 v26, v28, v29, vcc
    v_add_u32 v104, v103, v26
    v_add_u32 v27, 10, v27
    v_cmp_le_u32 vcc, 18, v27
    v_subrev_u32 v26, 18, v27
    s_nop 0
    v_cndmask_b32 v27, v27, v26, vcc
    v_cndmask_b32 v26, v28, v29, vcc
    v_add_u32 v105, v104, v26
    v_add_u32 v27, 10, v27
    v_cmp_le_u32 vcc, 18, v27
    v_subrev_u32 v26, 18, v27
    s_nop 0
    v_cndmask_b32 v27, v27, v26, vcc
    v_cndmask_b32 v26, v28, v29, vcc
    v_add_u32 v106, v105, v26
    v_add_u32 v27, 10, v27
    v_cmp_le_u32 vcc, 18, v27
    v_subrev_u32 v26, 18, v27
    s_nop 0
    v_cndmask_b32 v27, v27, v26, vcc
    v_cndmask_b32 v26, v28, v29, vcc
    v_add_u32 v107, v106, v26
    v_add_u32 v27, 10, v27
    v_cmp_le_u32 vcc, 18, v27
    v_subrev_u32 v26, 18, v27
    s_nop 0
    v_cndmask_b32 v27, v27, v26, vcc
    v_cndmask_b32 v26, v28, v29, vcc
    v_add_u32 v108, v107, v26
    v_add_u32 v27, 10, v27
    v_cmp_le_u32 vcc, 18, v27
    v_subrev_u32 v26, 18, v27
    s_nop 0
    v_cndmask_b32 v27, v27, v26, vcc
    v_cndmask_b32 v26, v28, v29, vcc
    v_add_u32 v109, v108, v26
    v_add_u32 v27, 10, v27
    v_cmp_le_u32 vcc, 18, v27
    v_subrev_u32 v26, 18, v27
    s_nop 0
    v_cndmask_b32 v27, v27, v26, vcc
    v_cndmask_b32 v26, v28, v29, vcc
    v_add_u32 v110, v109, v26
    v_add_u32 v27, 10, v27
    v_cmp_le_u32 vcc, 18, v27
    v_subrev_u32 v26, 18, v27
    s_nop 0
    v_cndmask_b32 v27, v27, v26, vcc
    v_cndmask_b32 v26, v28, v29, vcc
    v_add_u32 v111, v110, v26
    v_add_u32 v27, 10, v27
    v_cmp_le_u32 vcc, 18, v27
    v_subrev_u32 v26, 18, v27
    s_nop 0
    v_cndmask_b32 v27, v27, v26, vcc
    v_cndmask_b32 v26, v28, v29, vcc
    v_add_u32 v112, v111, v26
    v_add_u32 v27, 10, v27
    v_cmp_le_u32 vcc, 18, v27
    v_subrev_u32 v26, 18, v27
    s_nop 0
    v_cndmask_b32 v27, v27, v26, vcc
    v_cndmask_b32 v26, v28, v29, vcc
    v_add_u32 v113, v112, v26
    v_add_u32 v27, 10, v27
    v_cmp_le_u32 vcc, 18, v27
    v_subrev_u32 v26, 18, v27
    s_nop 0
    v_cndmask_b32 v27, v27, v26, vcc
    v_cndmask_b32 v26, v28, v29, vcc
    v_add_u32 v114, v113, v26
    v_add_u32 v27, 10, v27
    v_cmp_le_u32 vcc, 18, v27
    v_subrev_u32 v26, 18, v27
    s_nop 0
    v_cndmask_b32 v27, v27, v26, vcc
    v_cndmask_b32 v26, v28, v29, vcc
    v_add_u32 v115, v114, v26
    v_add_u32 v27, 10, v27
    v_cmp_le_u32 vcc, 18, v27
    v_subrev_u32 v26, 18, v27
    s_nop 0
    v_cndmask_b32 v27, v27, v26, vcc
    v_cndmask_b32 v26, v28, v29, vcc
    v_add_u32 v116, v115, v26
    v_add_u32 v27, 10, v27
    v_cmp_le_u32 vcc, 18, v27
    v_subrev_u32 v26, 18, v27
    s_nop 0
    v_cndmask_b32 v27, v27, v26, vcc
    v_cndmask_b32 v26, v28, v29, vcc
    v_add_u32 v117, v116, v26
    s_mov_b32 s30, 400000
L_sp_13:
    ds_read_b32 v16, v7 offset:49780
    s_waitcnt lgkmcnt(0)
    v_readfirstlane_b32 s84, v16
    s_cmp_eq_u32 s84, 8
    s_cbranch_scc1 L_sd_14
    s_sleep 2
    s_sub_u32 s30, s30, 1
    s_cbranch_scc0 L_sp_13
L_sd_14:
    s_mov_b32 m0, 18432
    s_nop 0
    buffer_load_dwordx4 v100, s[52:55], 0 offen nt lds
    s_mov_b32 m0, 19456
    s_nop 0
    buffer_load_dwordx4 v101, s[52:55], 0 offen nt lds
    s_mov_b32 m0, 20480
    s_nop 0
    buffer_load_dwordx4 v102, s[52:55], 0 offen nt lds
    s_mov_b32 m0, 21504
    s_nop 0
    buffer_load_dwordx4 v103, s[52:55], 0 offen nt lds
    s_mov_b32 m0, 22528
    s_nop 0
    buffer_load_dwordx4 v104, s[52:55], 0 offen nt lds
    s_mov_b32 m0, 23552
    s_nop 0
    buffer_load_dwordx4 v105, s[52:55], 0 offen nt lds
    s_mov_b32 m0, 24576
    s_nop 0
    buffer_load_dwordx4 v106, s[52:55], 0 offen nt lds
    s_mov_b32 m0, 25600
    s_nop 0
    buffer_load_dwordx4 v107, s[52:55], 0 offen nt lds
    s_mov_b32 m0, 26624
    s_nop 0
    buffer_load_dwordx4 v108, s[52:55], 0 offen nt lds
    s_mov_b32 m0, 27648
    s_nop 0
    buffer_load_dwordx4 v109, s[52:55], 0 offen nt lds
    s_mov_b32 m0, 28672
    s_nop 0
    buffer_load_dwordx4 v110, s[52:55], 0 offen nt lds
    s_mov_b32 m0, 29696
    s_nop 0
    buffer_load_dwordx4 v111, s[52:55], 0 offen nt lds
    s_mov_b32 m0, 30720
    s_nop 0
    buffer_load_dwordx4 v112, s[52:55], 0 offen nt lds
    s_mov_b32 m0, 31744
    s_nop 0
    buffer_load_dwordx4 v113, s[52:55], 0 offen nt lds
    s_mov_b32 m0, 32768
    s_nop 0
    buffer_load_dwordx4 v114, s[52:55], 0 offen nt lds
    s_mov_b32 m0, 33792
    s_nop 0
    buffer_load_dwordx4 v115, s[52:55], 0 offen nt lds
    s_mov_b32 m0, 34816
    s_nop 0
    buffer_load_dwordx4 v116, s[52:55], 0 offen nt lds
    s_mov_b32 m0, 35840
    s_nop 0
    buffer_load_dwordx4 v117, s[52:55], 0 offen nt lds
L_nowo:
    s_mov_b32 s30, 400000
L_sp_15:
    ds_read_b32 v16, v7 offset:49780
    s_waitcnt lgkmcnt(0)
    v_readfirstlane_b32 s84, v16
    s_cmp_eq_u32 s84, 8
    s_cbranch_scc1 L_sd_16
    s_sleep 2
    s_sub_u32 s30, s30, 1
    s_cbranch_scc0 L_sp_15
L_sd_16:
    s_mov_b32 s30, 200000
L_opoll:
    buffer_load_dwordx4 v[40:43], v15, s[40:43], 0 offen sc1
    s_waitcnt vmcnt(0)
    v_msad_u8 v20, v40, s100, 0
    v_msad_u8 v20, v41, s100, v20
    v_msad_u8 v20, v42, s100, v20
    v_msad_u8 v20, v43, s100, v20
    v_cmp_ne_u32 vcc, 0, v20
    v_and_b32 v40, 0xffffff00, v40
    v_and_b32 v41, 0xffffff00, v41
    v_and_b32 v42, 0xffffff00, v42
    v_and_b32 v43, 0xffffff00, v43
    v_mul_f32 v40, v40, v24
    v_mul_f32 v41, v41, v24
    v_mul_f32 v42, v42, v24
    v_mul_f32 v43, v43, v24
    s_sub_u32 s30, s30, 1
    s_cbranch_scc1 L_odone
    s_cbranch_vccnz L_opoll
L_odone:
    v_permlane32_swap_b32 v40, v41
    v_permlane32_swap_b32 v42, v43
    v_add_f32 v40, v40, v41
    v_add_f32 v42, v42, v43
    s_nop 1
    v_permlane16_swap_b32 v40, v42
    v_add_f32 v40, v40, v42
    v_cvt_pk_bf16_f32 v40, v40, v40
    ds_write_b16 v12, v40 offset:49184
    s_mov_b64 exec, 1
    ds_add_u32 v7, v6 offset:49768
    s_mov_b64 exec, -1
    s_cmp_ge_u32 s3, 3
    s_cbranch_scc1 L_pstage
    s_branch L_fin
L_s0:
    s_lshl_b32 s84, s76, 14
    s_lshl_b32 s85, s78, 12
    s_add_u32 s85, s85, s84
    s_add_u32 s85, s85, 327680
    v_lshl_add_u32 v15, v0, 4, s85
    s_mov_b32 s30, 200000
L_qpoll:
    s_cmp_ge_u32 s30, 199984
    s_cselect_b32 s83, 0, 884736
    buffer_load_dword v23, v22, s[40:43], s83 offen sc1
    buffer_load_dwordx4 v[40:43], v15, s[40:43], s83 offen offset:0 sc1
    buffer_load_dwordx4 v[44:47], v15, s[40:43], s83 offen offset:1024 sc1
    buffer_load_dwordx4 v[48:51], v15, s[40:43], s83 offen offset:2048 sc1
    buffer_load_dwordx4 v[52:55], v15, s[40:43], s83 offen offset:3072 sc1
    s_waitcnt vmcnt(4)
    v_xor_b32 v23, s86, v23
    v_and_b32 v20, 0xfffff0ff, v23
    v_min_u32 v20, 1, v20
    s_waitcnt vmcnt(3)
    v_msad_u8 v20, v40, s100, v20
    v_msad_u8 v20, v41, s100, v20
    v_msad_u8 v20, v42, s100, v20
    v_msad_u8 v20, v43, s100, v20
    v_and_b32 v40, 0xffffff00, v40
    v_and_b32 v41, 0xffffff00, v41
    v_and_b32 v42, 0xffffff00, v42
    v_and_b32 v43, 0xffffff00, v43
    s_waitcnt vmcnt(2)
    v_msad_u8 v20, v44, s100, v20
    v_msad_u8 v20, v45, s100, v20
    v_msad_u8 v20, v46, s100, v20
    v_msad_u8 v20, v47, s100, v20
    v_and_b32 v44, 0xffffff00, v44
    v_and_b32 v45, 0xffffff00, v45
    v_and_b32 v46, 0xffffff00, v46
    v_and_b32 v47, 0xffffff00, v47
    v_add_f32 v40, v40, v44
    v_add_f32 v41, v41, v45
    v_add_f32 v42, v42, v46
    v_add_f32 v43, v43, v47
    s_waitcnt vmcnt(1)
    v_msad_u8 v20, v48, s100, v20
    v_msad_u8 v20, v49, s100, v20
    v_msad_u8 v20, v50, s100, v20
    v_msad_u8 v20, v51, s100, v20
    v_and_b32 v48, 0xffffff00, v48
    v_and_b32 v49, 0xffffff00, v49
    v_and_b32 v50, 0xffffff00, v50
    v_and_b32 v51, 0xffffff00, v51
    v_add_f32 v40, v40, v48
    v_add_f32 v41, v41, v49
    v_add_f32 v42, v42, v50
    v_add_f32 v43, v43, v51
    s_waitcnt vmcnt(0)
    v_msad_u8 v20, v52, s100, v20
    v_msad_u8 v20, v53, s100, v20
    v_msad_u8 v20, v54, s100, v20
    v_msad_u8 v20, v55, s100, v20
    v_and_b32 v52, 0xffffff00, v52
    v_and_b32 v53, 0xffffff00, v53
    v_and_b32 v54, 0xffffff00, v54
    v_and_b32 v55, 0xffffff00, v55
    v_add_f32 v40, v40, v52
    v_add_f32 v41, v41, v53
    v_add_f32 v42, v42, v54
    v_add_f32 v43, v43, v55
    v_cmp_ne_u32 vcc, 0, v20
    s_sub_u32 s30, s30, 1
    s_cbranch_scc1 L_qpoll_d
    s_cbranch_vccnz L_qpoll
L_qpoll_d:
    v_cmp_ne_u32 vcc, 0, v23
    v_cvt_pk_bf16_f32 v40, v40, v41
    v_cvt_pk_bf16_f32 v41, v42, v43
    v_lshlrev_b32 v12, 3, v0
    ds_write_b64 v12, v[40:41] offset:41472
    s_cmp_eq_u64 vcc, 0
    s_cselect_b32 s87, 2, 1
    v_mov_b32 v13, s87
    ds_write_b32 v7, v13 offset:49760
    v_and_b32 v12, 1, v0
    v_lshlrev_b32 v13, 5, v12
    s_lshl_b32 s84, s81, 7
    s_add_u32 s84, s84, 32768
    v_lshl_add_u32 v12, v12, 4, s84
    s_mov_b32 s30, 400000
L_sp_17:
    ds_read_b32 v16, v7 offset:49776
    s_waitcnt lgkmcnt(0)
    v_readfirstlane_b32 s84, v16
    s_cmp_eq_u32 s84, 8
    s_cbranch_scc1 L_sd_18
    s_sleep 1
    s_sub_u32 s30, s30, 1
    s_cbranch_scc0 L_sp_17
L_sd_18:
    ds_read_b128 v[40:43], v13 offset:49056
    ds_read_b128 v[44:47], v13 offset:49072
    ds_read_b128 v[48:51], v13 offset:49120
    ds_read_b128 v[52:55], v13 offset:49136
    s_waitcnt lgkmcnt(0)
    v_max3_f32 v16, v40, v41, v42
    v_max3_f32 v16, v16, v43, v44
    v_max3_f32 v16, v16, v45, v46
    v_max_f32 v16, v16, v47
    v_sub_f32 v40, v40, v16
    v_sub_f32 v41, v41, v16
    v_sub_f32 v42, v42, v16
    v_sub_f32 v43, v43, v16
    v_sub_f32 v44, v44, v16
    v_sub_f32 v45, v45, v16
    v_sub_f32 v46, v46, v16
    v_sub_f32 v47, v47, v16
    v_exp_f32 v40, v40
    v_exp_f32 v41, v41
    v_exp_f32 v42, v42
    v_exp_f32 v43, v43
    v_exp_f32 v44, v44
    v_exp_f32 v45, v45
    v_exp_f32 v46, v46
    v_exp_f32 v47, v47
    v_mul_f32 v18, v40, v48
    v_fmac_f32 v18, v41, v49
    v_fmac_f32 v18, v42, v50
    v_fmac_f32 v18, v43, v51
    v_fmac_f32 v18, v44, v52
    v_fmac_f32 v18, v45, v53
    v_fmac_f32 v18, v46, v54
    v_fmac_f32 v18, v47, v55
    v_mov_b32 v17, s80
    v_mov_b32 v19, s80
    s_mov_b64 exec, 3
    s_cmp_eq_u32 s87, 2
    s_cbranch_scc1 L_stpub_l
    buffer_store_dwordx4 v[16:19], v12, s[40:43], 0 offen sc1
    s_branch L_stpub_d
L_stpub_l:
    buffer_store_dwordx4 v[16:19], v12, s[40:43], 0 offen
L_stpub_d:
    s_mov_b64 exec, -1
L_final:
    s_setprio 0
    s_cmp_ge_u32 s2, 144
    s_cbranch_scc1 L_fin
    s_mov_b32 s68, s24
    s_mov_b32 s69, s25
    s_mov_b32 s70, 0x1200
    s_mov_b32 s71, 0x20000
    v_and_b32 v9, 3, v0
    v_lshlrev_b32 v9, 2, v9
    v_bfe_u32 v12, v0, 4, 1
    v_lshl_add_u32 v9, v12, 1, v9
    v_lshrrev_b32 v12, 5, v0
    v_add_u32 v9, v9, v12
    s_lshl_b32 s84, s2, 4
    v_add_u32 v9, s84, v9
    v_lshlrev_b32 v35, 3, v9
    v_add_u32 v35, 4096, v35
    v_lshlrev_b32 v9, 1, v9
    buffer_load_ushort v2, v9, s[44:47], 0 offen
    s_lshl_b32 s84, s2, 12
    s_add_u32 s84, s84, 589824
    v_lshl_add_u32 v36, v0, 4, s84
    s_mov_b32 s30, 400000
L_sp_19:
    ds_read_b32 v16, v7 offset:49784
    s_waitcnt lgkmcnt(0)
    v_readfirstlane_b32 s84, v16
    s_cmp_eq_u32 s84, 3
    s_cbranch_scc1 L_sd_20
    s_sleep 8
    s_sub_u32 s30, s30, 1
    s_cbranch_scc0 L_sp_19
L_sd_20:
    s_mov_b32 s30, 200000
L_gpoll:
    buffer_load_dwordx2 v[32:33], v35, s[40:43], 0 offen sc1
    s_waitcnt vmcnt(0)
    v_cmp_ne_u32 vcc, s80, v33
    s_sub_u32 s30, s30, 1
    s_cbranch_scc1 L_gdone
    s_cbranch_vccz L_gdone
    s_sleep 8
    s_branch L_gpoll
L_gdone:
    v_lshlrev_b32 v2, 16, v2
    s_mov_b32 s30, 400000
L_sp_21:
    ds_read_b32 v16, v7 offset:49788
    s_waitcnt lgkmcnt(0)
    v_readfirstlane_b32 s84, v16
    s_cmp_eq_u32 s84, 9
    s_cbranch_scc1 L_sd_22
    s_sleep 1
    s_sub_u32 s30, s30, 1
    s_cbranch_scc0 L_sp_21
L_sd_22:
    s_mov_b32 s30, 200000
    buffer_load_dwordx4 v[40:43], v36, s[40:43], 0 offen offset:0 sc1
    buffer_load_dwordx4 v[44:47], v36, s[40:43], 0 offen offset:1024 sc1
    buffer_load_dwordx4 v[48:51], v36, s[40:43], 0 offen offset:2048 sc1
    buffer_load_dwordx4 v[52:55], v36, s[40:43], 0 offen offset:3072 sc1
L_fpoll:
    buffer_load_dwordx4 v[56:59], v36, s[40:43], 0 offen offset:0 sc1
    buffer_load_dwordx4 v[60:63], v36, s[40:43], 0 offen offset:1024 sc1
    buffer_load_dwordx4 v[64:67], v36, s[40:43], 0 offen offset:2048 sc1
    buffer_load_dwordx4 v[68:71], v36, s[40:43], 0 offen offset:3072 sc1
    s_waitcnt vmcnt(7)
    v_msad_u8 v20, v40, s100, 0
    v_msad_u8 v20, v41, s100, v20
    v_msad_u8 v20, v42, s100, v20
    v_msad_u8 v20, v43, s100, v20
    v_and_b32 v40, 0xffffff00, v40
    v_and_b32 v41, 0xffffff00, v41
    v_and_b32 v42, 0xffffff00, v42
    v_and_b32 v43, 0xffffff00, v43
    s_waitcnt vmcnt(6)
    v_msad_u8 v20, v44, s100, v20
    v_msad_u8 v20, v45, s100, v20
    v_msad_u8 v20, v46, s100, v20
    v_msad_u8 v20, v47, s100, v20
    v_and_b32 v44, 0xffffff00, v44
    v_and_b32 v45, 0xffffff00, v45
    v_and_b32 v46, 0xffffff00, v46
    v_and_b32 v47, 0xffffff00, v47
    v_add_f32 v40, v40, v44
    v_add_f32 v41, v41, v45
    v_add_f32 v42, v42, v46
    v_add_f32 v43, v43, v47
    s_waitcnt vmcnt(5)
    v_msad_u8 v20, v48, s100, v20
    v_msad_u8 v20, v49, s100, v20
    v_msad_u8 v20, v50, s100, v20
    v_msad_u8 v20, v51, s100, v20
    v_and_b32 v48, 0xffffff00, v48
    v_and_b32 v49, 0xffffff00, v49
    v_and_b32 v50, 0xffffff00, v50
    v_and_b32 v51, 0xffffff00, v51
    s_waitcnt vmcnt(4)
    v_msad_u8 v20, v52, s100, v20
    v_msad_u8 v20, v53, s100, v20
    v_msad_u8 v20, v54, s100, v20
    v_msad_u8 v20, v55, s100, v20
    v_and_b32 v52, 0xffffff00, v52
    v_and_b32 v53, 0xffffff00, v53
    v_and_b32 v54, 0xffffff00, v54
    v_and_b32 v55, 0xffffff00, v55
    v_add_f32 v48, v48, v52
    v_add_f32 v49, v49, v53
    v_add_f32 v50, v50, v54
    v_add_f32 v51, v51, v55
    v_cmp_ne_u32 vcc, 0, v20
    v_add_f32 v24, v40, v48
    v_add_f32 v25, v41, v49
    v_add_f32 v26, v42, v50
    v_add_f32 v27, v43, v51
    s_cbranch_vccz L_fpoll_d
    buffer_load_dwordx4 v[40:43], v36, s[40:43], 0 offen offset:0 sc1
    buffer_load_dwordx4 v[44:47], v36, s[40:43], 0 offen offset:1024 sc1
    buffer_load_dwordx4 v[48:51], v36, s[40:43], 0 offen offset:2048 sc1
    buffer_load_dwordx4 v[52:55], v36, s[40:43], 0 offen offset:3072 sc1
    s_waitcnt vmcnt(7)
    v_msad_u8 v20, v56, s100, 0
    v_msad_u8 v20, v57, s100, v20
    v_msad_u8 v20, v58, s100, v20
    v_msad_u8 v20, v59, s100, v20
    v_and_b32 v56, 0xffffff00, v56
    v_and_b32 v57, 0xffffff00, v57
    v_and_b32 v58, 0xffffff00, v58
    v_and_b32 v59, 0xffffff00, v59
    s_waitcnt vmcnt(6)
    v_msad_u8 v20, v60, s100, v20
    v_msad_u8 v20, v61, s100, v20
    v_msad_u8 v20, v62, s100, v20
    v_msad_u8 v20, v63, s100, v20
    v_and_b32 v60, 0xffffff00, v60
    v_and_b32 v61, 0xffffff00, v61
    v_and_b32 v62, 0xffffff00, v62
    v_and_b32 v63, 0xffffff00, v63
    v_add_f32 v56, v56, v60
    v_add_f32 v57, v57, v61
    v_add_f32 v58, v58, v62
    v_add_f32 v59, v59, v63
    s_waitcnt vmcnt(5)
    v_msad_u8 v20, v64, s100, v20
    v_msad_u8 v20, v65, s100, v20
    v_msad_u8 v20, v66, s100, v20
    v_msad_u8 v20, v67, s100, v20
    v_and_b32 v64, 0xffffff00, v64
    v_and_b32 v65, 0xffffff00, v65
    v_and_b32 v66, 0xffffff00, v66
    v_and_b32 v67, 0xffffff00, v67
    s_waitcnt vmcnt(4)
    v_msad_u8 v20, v68, s100, v20
    v_msad_u8 v20, v69, s100, v20
    v_msad_u8 v20, v70, s100, v20
    v_msad_u8 v20, v71, s100, v20
    v_and_b32 v68, 0xffffff00, v68
    v_and_b32 v69, 0xffffff00, v69
    v_and_b32 v70, 0xffffff00, v70
    v_and_b32 v71, 0xffffff00, v71
    v_add_f32 v64, v64, v68
    v_add_f32 v65, v65, v69
    v_add_f32 v66, v66, v70
    v_add_f32 v67, v67, v71
    v_cmp_ne_u32 vcc, 0, v20
    v_add_f32 v24, v56, v64
    v_add_f32 v25, v57, v65
    v_add_f32 v26, v58, v66
    v_add_f32 v27, v59, v67
    s_cbranch_vccz L_fpoll_d
    s_sub_u32 s30, s30, 1
    s_cbranch_scc0 L_fpoll
L_fpoll_d:
    s_nop 0
    v_permlane32_swap_b32 v24, v25
    v_permlane32_swap_b32 v26, v27
    v_add_f32 v24, v24, v25
    v_add_f32 v26, v26, v27
    s_nop 1
    v_permlane16_swap_b32 v24, v26
    v_add_f32 v24, v24, v26
    s_nop 1
    v_add_f32_dpp v24, v24, v24 row_ror:4 row_mask:0xf bank_mask:0xf
    s_nop 1
    v_add_f32_dpp v24, v24, v24 row_ror:8 row_mask:0xf bank_mask:0xf
    v_cvt_pk_bf16_f32 v24, v24, v24
    v_and_b32 v24, 0xffff0000, v24
    v_mul_f32 v24, v24, v32
    v_cvt_pk_bf16_f32 v24, v24, v24
    v_and_b32 v24, 0xffff0000, v24
    v_add_f32 v24, v24, v2
    v_cvt_pk_bf16_f32 v24, v24, v24
    s_mov_b32 exec_lo, 0x000f000f
    s_mov_b32 exec_hi, 0x000f000f
    buffer_store_short v24, v9, s[68:71], 0 offen
    s_cmp_lg_u32 s2, 0
    s_cbranch_scc1 L_noep
    s_mov_b64 exec, 1
    v_mov_b32 v25, s80
    buffer_store_dword v25, v7, s[40:43], 0 offen offset:0 sc1
L_noep:
    s_mov_b64 exec, -1
L_fin:
L_end:
    s_endpgm
L_codeend:
.section .rodata,"a"
.p2align 6
.amdhsa_kernel recurrent_scan__sliding_block_cached__mixer_token_mlp__decode_kernel
  .amdhsa_next_free_vgpr 168
  .amdhsa_next_free_sgpr 102
  .amdhsa_accum_offset 168
  .amdhsa_group_segment_fixed_size 0
  .amdhsa_kernarg_size 104
  .amdhsa_user_sgpr_count 2
  .amdhsa_user_sgpr_kernarg_segment_ptr 1
  .amdhsa_system_sgpr_workgroup_id_x 1
.end_amdhsa_kernel
```
